```python
import torch

def _softmax(x, axis=-1):
    return torch.softmax(x, dim=axis)
def _gelu(x):
    return torch.nn.functional.gelu(x, approximate="tanh")
def _silu(x):
    return torch.nn.functional.silu(x)
def _sigmoid(x):
    return torch.sigmoid(x)
def _layernorm(x, axis=-1, eps=1e-5):
    m = x.mean(dim=axis, keepdim=True)
    v = x.var(dim=axis, keepdim=True, unbiased=False)
    return (x - m) / torch.sqrt(v + eps)
def _scatter_add(tgt, idx, src, axis=0):
    return tgt.clone().index_add_(axis, idx, src)
def _segment_sum(src, seg, n):
    out = torch.zeros((n,) + src.shape[1:], dtype=src.dtype)
    return out.index_add_(0, seg, src)
def _pad(x, pw):
    flat = tuple(v for pair in reversed(pw) for v in pair)
    return torch.nn.functional.pad(x, flat)

kernel_name = 'interleave_layers__sliding_block__moe_arch_mod__prompt'

def setup_inputs():

    _w = (lambda a: (lambda t: t.to(torch.bfloat16) if t.is_floating_point() else t)(torch.as_tensor(a)))
    def _A_setup():
        B, S, D = 1, 2048, 640
        return {
            "x": _w((lambda *s: torch.randn(*s, dtype=torch.bfloat16) * 0.05)(B, S, D)),
            "wqkv": _w((lambda *s: torch.randn(*s, dtype=torch.bfloat16) * 0.05)(D, 3 * D)),
            "wo": _w((lambda *s: torch.randn(*s, dtype=torch.bfloat16) * 0.05)(D, D)),
        }
    _A_in = _A_setup()

    def _B_setup():
        B, S, D, F, C = 1, 2048, 640, 1536, 8
        return {
            "x": _w((lambda *s: torch.randn(*s, dtype=torch.bfloat16) * 0.05)(B, S, D)),
            "w_r": _w((lambda *s: torch.randn(*s, dtype=torch.bfloat16) * 0.05)(D)),
            "w_gate": _w((lambda *s: torch.randn(*s, dtype=torch.bfloat16) * 0.05)(D, F)),
            "w_up": _w((lambda *s: torch.randn(*s, dtype=torch.bfloat16) * 0.05)(D, F)),
            "w_down": _w((lambda *s: torch.randn(*s, dtype=torch.bfloat16) * 0.05)(F, D)),
        }
    _B_in = _B_setup()

    return {
        "A_x": _A_in["x"],
        "A_wqkv": _A_in["wqkv"],
        "A_wo": _A_in["wo"],
        "B_x": _B_in["x"],
        "B_w_r": _B_in["w_r"],
        "B_w_gate": _B_in["w_gate"],
        "B_w_up": _B_in["w_up"],
        "B_w_down": _B_in["w_down"],
    }

def reference(A_x, A_wqkv, A_wo, B_x, B_w_r, B_w_gate, B_w_up, B_w_down):
    def _A_ref(x, wqkv, wo):
        B, S, D = x.shape
        H = 32; Dh = D // H; W = 256
        qkv = (lambda x, *d: x.permute(*d))((x @ wqkv).reshape(B, S, 3, H, Dh), 2, 0, 3, 1, 4)
        q, k, v = qkv[0], qkv[1], qkv[2]
        scores = torch.einsum("bhqd,bhkd->bhqk", q, k) * (Dh ** -0.5)
        idx = torch.arange(S)
        mask = (idx[:, None] - idx[None, :] >= 0) & (idx[:, None] - idx[None, :] < W)
        scores = torch.where(mask[None, None], scores, -1e9)
        p = _softmax(scores, axis=-1)
        o = torch.einsum("bhqk,bhkd->bhqd", p, v)
        return (lambda x, *d: x.permute(*d))(o, 0, 2, 1, 3).reshape(B, S, D) @ wo

    def _B_ref(x, w_r, w_gate, w_up, w_down):
        B, S, D = x.shape
        C = 8
        r = x @ w_r
        idx = torch.argsort(-r, axis=-1)[:, :C]
        idx_e = (lambda x, n, axis: torch.repeat_interleave(x, n, dim=axis))(idx.reshape(B, C, 1), D, axis=2)
        x_sel = (lambda x, i, axis: torch.take_along_dim(x, i, dim=axis))(x, idx_e, axis=1)
        g = _silu(x_sel @ w_gate)
        u = x_sel @ w_up
        y = (g * u) @ w_down
        r_sel = _sigmoid((lambda x, i, axis: torch.take_along_dim(x, i, dim=axis))(r, idx, axis=1))
        y = y * r_sel.reshape(B, C, 1)
        b_off = (torch.arange(B) * S).reshape(B, 1)
        flat_idx = (idx + b_off).reshape(B * C)
        zero = (x * 0.0).reshape(B * S, D)
        upd = _scatter_add(zero, flat_idx, y.reshape(B * C, D), axis=0)
        return x + upd.reshape(B, S, D)

    x = A_x
    x = x + _A_ref(_layernorm(x, axis=-1), A_wqkv, A_wo)
    x = x + _B_ref(_layernorm(x, axis=-1), B_w_r, B_w_gate, B_w_up, B_w_down)
    x = x + _A_ref(_layernorm(x, axis=-1), A_wqkv, A_wo)
    x = x + _B_ref(_layernorm(x, axis=-1), B_w_r, B_w_gate, B_w_up, B_w_down)
    return x
```

```asm
; @launch grid=(256,1,1) block=(512,1,1) lds=163840
.amdgcn_target "amdgcn-amd-amdhsa--gfx950"
.text
.globl interleave_layers__sliding_block__moe_arch_mod__prompt_kernel
.p2align 8
.type interleave_layers__sliding_block__moe_arch_mod__prompt_kernel,@function
interleave_layers__sliding_block__moe_arch_mod__prompt_kernel:
    s_cmp_ge_u32 s2, 256
    s_cbranch_scc1 L_END
    s_load_dwordx2 s[8:9], s[0:1], 0
    s_load_dwordx2 s[12:13], s[0:1], 8
    s_load_dwordx2 s[20:21], s[0:1], 80
    s_load_dwordx2 s[16:17], s[0:1], 16
    s_load_dwordx2 s[24:25], s[0:1], 64
    s_load_dwordx2 s[42:43], s[0:1], 32
    s_load_dwordx2 s[46:47], s[0:1], 40
    s_load_dwordx2 s[48:49], s[0:1], 48
    s_load_dwordx2 s[96:97], s[0:1], 56
    v_mov_b32 v254, v0
    v_and_b32 v253, 63, v0
    v_lshrrev_b32 v1, 6, v0
    s_and_b32 s32, s2, 7
    s_lshr_b32 s33, s2, 3
    v_readfirstlane_b32 s6, v1
    s_mov_b32 s3, 0
    s_mov_b32 s34, 0
    s_mov_b32 s7, 4194304
    s_mov_b32 s35, 0x3f803f80
    s_mov_b32 s10, 2621440
    s_mov_b32 s11, 0x20000
    s_mov_b32 s14, 2457600
    s_mov_b32 s15, 0x20000
    s_mov_b32 s18, 819200
    s_mov_b32 s19, 0x20000
    s_mov_b32 s22, 40894464
    s_mov_b32 s23, 0x20000
    s_mov_b32 s26, 2621440
    s_mov_b32 s27, 0x20000
    s_mov_b32 s31, 0x20000
    s_lshl_b32 s38, s32, 2
    s_and_b32 s82, s33, 3
    s_add_u32 s38, s38, s82
    s_lshr_b32 s39, s33, 2
    s_lshl_b32 s44, s32, 1
    s_and_b32 s82, s33, 1
    s_add_u32 s44, s44, s82
    s_mul_i32 s41, s32, 6
    s_add_u32 s41, s41, s33
    s_sub_u32 s41, s41, 24
    s_sub_u32 s82, s33, 24
    s_cmp_ge_u32 s82, 6
    s_cmov_b32 s41, 48
L_LAYER:
    s_cmp_lt_u32 s33, 24
    s_cbranch_scc1 L_QKV_WORK
    s_cmp_lg_u32 s3, 0
    s_cbranch_scc1 L_QKV_END
    s_cmp_lg_u32 s6, 7
    s_cbranch_scc1 L_PC2A
    s_getpc_b64 s[92:93]
L_PCA:
    s_sub_u32 s92, s92, L_PCA-interleave_layers__sliding_block__moe_arch_mod__prompt_kernel
    s_subb_u32 s93, s93, 0
    s_sub_u32 s82, s33, 24
    s_lshl_b32 s82, s82, 13
    v_lshlrev_b32 v70, 7, v253
    v_add_u32 v70, s82, v70
    v_min_u32 v70, L_END-interleave_layers__sliding_block__moe_arch_mod__prompt_kernel, v70
    global_load_dword v71, v70, s[92:93]
L_PC2A:
    s_mov_b32 s54, 1966080
    s_mov_b32 s55, 0x20000
    v_mov_b32 v56, 0
    v_mov_b32 v57, 0
    v_mov_b32 v58, 0
    v_mov_b32 v59, 0
    v_lshlrev_b32 v65, 4, v254
    s_sub_u32 s84, s2, 192
    s_lshl_b32 s84, s84, 13
    s_waitcnt lgkmcnt(0)
    s_mov_b32 s82, 1114048
    s_load_dword s45, s[20:21], s82
    buffer_store_dwordx4 v[56:59], v65, s[20:23], s84 offen sc1
    s_lshl_b32 s84, s32, 2
    s_and_b32 s85, s33, 3
    s_add_u32 s84, s84, s85
    s_lshl_b32 s84, s84, 3
    s_lshr_b32 s85, s33, 2
    s_add_u32 s84, s84, s85
    s_mul_i32 s84, s84, 512
    s_cmp_lg_u32 s6, 0
    s_cbranch_scc1 L_HZ
    s_mov_b32 exec_hi, 0
    buffer_store_dwordx4 v[56:59], v65, s[20:23], s84 offen sc1
    s_mov_b64 exec, -1
L_HZ:
    s_sub_u32 s86, s2, 192
    v_lshrrev_b32 v60, 4, v253
    v_mul_u32_u24 v61, 1280, v60
    v_and_b32 v62, 15, v253
    v_lshl_add_u32 v61, v62, 4, v61
    s_lshl_b32 s83, s32, 3
    s_and_b32 s83, s32, 1
    s_lshl_b32 s83, s83, 5
    s_lshr_b32 s84, s32, 1
    s_lshl_b32 s84, s84, 3
    s_add_u32 s83, s83, s84
    s_add_u32 s83, s83, s33
    s_sub_u32 s83, s83, 24
    s_lshl_b32 s83, s83, 3
    s_add_u32 s83, s83, s6
    s_mul_i32 s84, s83, 5120
    buffer_load_dwordx4 v[0:3], v61, s[8:11], s84 offen offset:0
    buffer_load_dwordx4 v[4:7], v61, s[8:11], s84 offen offset:256
    buffer_load_dwordx4 v[8:11], v61, s[8:11], s84 offen offset:512
    buffer_load_dwordx4 v[12:15], v61, s[8:11], s84 offen offset:768
    buffer_load_dwordx4 v[16:19], v61, s[8:11], s84 offen offset:1024
    s_and_b32 s85, s32, 1
    s_lshl_b32 s85, s85, 3
    s_add_u32 s85, s85, s33
    s_sub_u32 s85, s85, 24
    s_min_u32 s85, s85, 14
    s_mul_i32 s84, s85, 52
    s_lshr_b32 s84, s84, 8
    s_mul_i32 s84, s84, 15
    s_add_u32 s85, s85, s84
    s_lshr_b32 s84, s32, 1
    s_mul_i32 s84, s84, 5
    s_add_u32 s85, s85, s84
    s_and_b32 s84, s85, 1
    s_lshl_b32 s84, s84, 3
    s_add_u32 s84, s84, s6
    s_mul_i32 s84, s84, 153600
    s_lshr_b32 s87, s85, 1
    s_lshl_b32 s87, s87, 7
    s_add_u32 s84, s84, s87
    v_lshrrev_b32 v63, 3, v253
    v_mul_u32_u24 v63, 3840, v63
    v_and_b32 v64, 7, v253
    v_lshl_add_u32 v63, v64, 4, v63
    buffer_load_dwordx4 v[20:23], v63, s[12:15], s84 offen
    s_add_u32 s84, s84, 30720
    buffer_load_dwordx4 v[24:27], v63, s[12:15], s84 offen
    s_add_u32 s84, s84, 30720
    buffer_load_dwordx4 v[28:31], v63, s[12:15], s84 offen
    s_add_u32 s84, s84, 30720
    buffer_load_dwordx4 v[32:35], v63, s[12:15], s84 offen
    s_add_u32 s84, s84, 30720
    buffer_load_dwordx4 v[36:39], v63, s[12:15], s84 offen
    s_add_u32 s84, s84, 30720
    s_sub_u32 s88, s33, 24
    s_lshl_b32 s88, s88, 2
    s_and_b32 s89, s6, 3
    s_add_u32 s88, s88, s89
    s_mul_i32 s88, s88, 61440
    s_mul_i32 s89, s32, 384
    s_add_u32 s88, s88, s89
    v_min_u32 v66, 59, v253
    v_mul_u32_u24 v67, 86, v66
    v_lshrrev_b32 v67, 8, v67
    v_mul_u32_u24 v67, 2688, v67
    v_lshl_add_u32 v66, v66, 7, v67
L_HT_G:
    s_mov_b64 s[56:57], s[42:43]
    s_cmp_lt_u32 s6, 4
    s_cselect_b64 s[52:53], s[46:47], s[48:49]
    s_mov_b32 s58, 1280
    s_mov_b32 s59, 0x20000
    s_mov_b32 s90, s83
    s_mov_b32 s91, s85
    s_mov_b32 s92, s87
    s_min_u32 s83, s6, 4
    s_lshl_b32 s83, s83, 6
    v_add_u32 v72, s83, v253
    v_mul_u32_u24 v73, 205, v72
    v_lshrrev_b32 v73, 11, v73
    v_mul_u32_u24 v74, 10, v73
    v_sub_u32 v72, v72, v74
    v_lshlrev_b32 v72, 4, v72
    v_and_b32 v74, 3, v73
    v_lshrrev_b32 v75, 4, v73
    v_bfe_u32 v76, v73, 2, 2
    v_mul_u32_u24 v77, 40, v76
    v_mad_u32_u24 v77, v75, 20, v77
    v_add3_u32 v77, v77, v74, 16
    v_lshl_add_u32 v74, v75, 2, v74
    v_bfe_u32 v75, v73, 3, 1
    v_mad_u32_u24 v74, v75, 20, v74
    v_and_b32 v76, 1, v76
    v_lshl_add_u32 v74, v76, 3, v74
    v_mul_u32_u24 v74, 1280, v74
    v_mul_u32_u24 v77, 1280, v77
    v_add_u32 v74, v72, v74
    v_add_u32 v77, v72, v77
    s_sub_u32 s83, s2, 192
    s_min_u32 s83, s83, 159
    s_mul_i32 s84, s83, 205
    s_lshr_b32 s84, s84, 11
    s_mul_i32 s85, s84, 10
    s_sub_u32 s85, s83, s85
    s_and_b32 s87, s84, 1
    s_mul_i32 s87, s87, 409600
    s_lshr_b32 s84, s84, 1
    s_mul_i32 s84, s84, 160
    s_add_u32 s84, s84, s87
    s_mul_i32 s87, s85, 51200
    s_sub_u32 s83, s85, 8
    s_mul_i32 s83, s83, 204800
    s_cmp_ge_u32 s85, 8
    s_cselect_b32 s87, s83, s87
    s_cselect_b64 vcc, -1, 0
    s_add_u32 s84, s84, s87
    v_cndmask_b32 v72, v74, v77, vcc
    buffer_load_dwordx4 v[80:83], v72, s[16:19], s84 offen
    s_sub_u32 s83, s2, 128
    s_min_u32 s83, s83, 159
    s_mul_i32 s84, s83, 205
    s_lshr_b32 s84, s84, 11
    s_mul_i32 s85, s84, 10
    s_sub_u32 s85, s83, s85
    s_and_b32 s87, s84, 1
    s_mul_i32 s87, s87, 409600
    s_lshr_b32 s84, s84, 1
    s_mul_i32 s84, s84, 160
    s_add_u32 s84, s84, s87
    s_mul_i32 s87, s85, 51200
    s_sub_u32 s83, s85, 8
    s_mul_i32 s83, s83, 204800
    s_cmp_ge_u32 s85, 8
    s_cselect_b32 s87, s83, s87
    s_cselect_b64 vcc, -1, 0
    s_add_u32 s84, s84, s87
    v_cndmask_b32 v72, v74, v77, vcc
    buffer_load_dwordx4 v[84:87], v72, s[16:19], s84 offen
    s_sub_u32 s83, s2, 64
    s_min_u32 s83, s83, 159
    s_mul_i32 s84, s83, 205
    s_lshr_b32 s84, s84, 11
    s_mul_i32 s85, s84, 10
    s_sub_u32 s85, s83, s85
    s_and_b32 s87, s84, 1
    s_mul_i32 s87, s87, 409600
    s_lshr_b32 s84, s84, 1
    s_mul_i32 s84, s84, 160
    s_add_u32 s84, s84, s87
    s_mul_i32 s87, s85, 51200
    s_sub_u32 s83, s85, 8
    s_mul_i32 s83, s83, 204800
    s_cmp_ge_u32 s85, 8
    s_cselect_b32 s87, s83, s87
    s_cselect_b64 vcc, -1, 0
    s_add_u32 s84, s84, s87
    v_cndmask_b32 v72, v74, v77, vcc
    buffer_load_dwordx4 v[88:91], v72, s[16:19], s84 offen
    s_waitcnt lgkmcnt(0)
    s_mul_i32 s45, s45, 0x9e3779b1
    s_add_u32 s45, s45, 0x7f4a7c15
    v_lshlrev_b32 v92, 2, v253
    buffer_load_dword v96, v92, s[56:59], 0 offen offset:0
    buffer_load_dword v97, v92, s[56:59], 0 offen offset:256
    buffer_load_dword v98, v92, s[56:59], 0 offen offset:512
    buffer_load_dword v99, v92, s[56:59], 0 offen offset:768
    buffer_load_dword v100, v92, s[56:59], 0 offen offset:1024
    s_waitcnt vmcnt(18)
    s_barrier
    s_cmp_lg_u32 s6, 7
    s_cbranch_scc1 L_HT_A
    s_sub_u32 s83, s2, 192
    s_lshl_b32 s83, s83, 2
    s_add_u32 s83, s83, 1114112
    v_mov_b32 v68, s45
    s_mov_b64 exec, 1
    buffer_store_dword v68, v56, s[20:23], s83 offen sc1
    s_mov_b64 exec, -1
L_HT_A:
    s_mov_b32 s83, s90
    s_mov_b32 s85, s91
    s_mov_b32 s87, s92
    v_mov_b32 v40, 0
    v_mov_b32 v42, 0
    v_mov_b32 v44, 0
    v_mov_b32 v45, 0
    s_waitcnt vmcnt(13)
    v_lshlrev_b32 v46, 16, v0
    v_and_b32 v47, 0xffff0000, v0
    v_add_f32 v40, v40, v46
    v_fmac_f32 v42, v46, v46
    v_add_f32 v44, v44, v47
    v_fmac_f32 v45, v47, v47
    v_lshlrev_b32 v48, 16, v1
    v_and_b32 v49, 0xffff0000, v1
    v_add_f32 v40, v40, v48
    v_fmac_f32 v42, v48, v48
    v_add_f32 v44, v44, v49
    v_fmac_f32 v45, v49, v49
    v_lshlrev_b32 v46, 16, v2
    v_and_b32 v47, 0xffff0000, v2
    v_add_f32 v40, v40, v46
    v_fmac_f32 v42, v46, v46
    v_add_f32 v44, v44, v47
    v_fmac_f32 v45, v47, v47
    v_lshlrev_b32 v48, 16, v3
    v_and_b32 v49, 0xffff0000, v3
    v_add_f32 v40, v40, v48
    v_fmac_f32 v42, v48, v48
    v_add_f32 v44, v44, v49
    v_fmac_f32 v45, v49, v49
    v_lshlrev_b32 v46, 16, v4
    v_and_b32 v47, 0xffff0000, v4
    v_add_f32 v40, v40, v46
    v_fmac_f32 v42, v46, v46
    v_add_f32 v44, v44, v47
    v_fmac_f32 v45, v47, v47
    v_lshlrev_b32 v48, 16, v5
    v_and_b32 v49, 0xffff0000, v5
    v_add_f32 v40, v40, v48
    v_fmac_f32 v42, v48, v48
    v_add_f32 v44, v44, v49
    v_fmac_f32 v45, v49, v49
    v_lshlrev_b32 v46, 16, v6
    v_and_b32 v47, 0xffff0000, v6
    v_add_f32 v40, v40, v46
    v_fmac_f32 v42, v46, v46
    v_add_f32 v44, v44, v47
    v_fmac_f32 v45, v47, v47
    v_lshlrev_b32 v48, 16, v7
    v_and_b32 v49, 0xffff0000, v7
    v_add_f32 v40, v40, v48
    v_fmac_f32 v42, v48, v48
    v_add_f32 v44, v44, v49
    v_fmac_f32 v45, v49, v49
    v_lshlrev_b32 v46, 16, v8
    v_and_b32 v47, 0xffff0000, v8
    v_add_f32 v40, v40, v46
    v_fmac_f32 v42, v46, v46
    v_add_f32 v44, v44, v47
    v_fmac_f32 v45, v47, v47
    v_lshlrev_b32 v48, 16, v9
    v_and_b32 v49, 0xffff0000, v9
    v_add_f32 v40, v40, v48
    v_fmac_f32 v42, v48, v48
    v_add_f32 v44, v44, v49
    v_fmac_f32 v45, v49, v49
    v_lshlrev_b32 v46, 16, v10
    v_and_b32 v47, 0xffff0000, v10
    v_add_f32 v40, v40, v46
    v_fmac_f32 v42, v46, v46
    v_add_f32 v44, v44, v47
    v_fmac_f32 v45, v47, v47
    v_lshlrev_b32 v48, 16, v11
    v_and_b32 v49, 0xffff0000, v11
    v_add_f32 v40, v40, v48
    v_fmac_f32 v42, v48, v48
    v_add_f32 v44, v44, v49
    v_fmac_f32 v45, v49, v49
    v_lshlrev_b32 v46, 16, v12
    v_and_b32 v47, 0xffff0000, v12
    v_add_f32 v40, v40, v46
    v_fmac_f32 v42, v46, v46
    v_add_f32 v44, v44, v47
    v_fmac_f32 v45, v47, v47
    v_lshlrev_b32 v48, 16, v13
    v_and_b32 v49, 0xffff0000, v13
    v_add_f32 v40, v40, v48
    v_fmac_f32 v42, v48, v48
    v_add_f32 v44, v44, v49
    v_fmac_f32 v45, v49, v49
    v_lshlrev_b32 v46, 16, v14
    v_and_b32 v47, 0xffff0000, v14
    v_add_f32 v40, v40, v46
    v_fmac_f32 v42, v46, v46
    v_add_f32 v44, v44, v47
    v_fmac_f32 v45, v47, v47
    v_lshlrev_b32 v48, 16, v15
    v_and_b32 v49, 0xffff0000, v15
    v_add_f32 v40, v40, v48
    v_fmac_f32 v42, v48, v48
    v_add_f32 v44, v44, v49
    v_fmac_f32 v45, v49, v49
    v_lshlrev_b32 v46, 16, v16
    v_and_b32 v47, 0xffff0000, v16
    v_add_f32 v40, v40, v46
    v_fmac_f32 v42, v46, v46
    v_add_f32 v44, v44, v47
    v_fmac_f32 v45, v47, v47
    v_lshlrev_b32 v48, 16, v17
    v_and_b32 v49, 0xffff0000, v17
    v_add_f32 v40, v40, v48
    v_fmac_f32 v42, v48, v48
    v_add_f32 v44, v44, v49
    v_fmac_f32 v45, v49, v49
    v_lshlrev_b32 v46, 16, v18
    v_and_b32 v47, 0xffff0000, v18
    v_add_f32 v40, v40, v46
    v_fmac_f32 v42, v46, v46
    v_add_f32 v44, v44, v47
    v_fmac_f32 v45, v47, v47
    v_lshlrev_b32 v48, 16, v19
    v_and_b32 v49, 0xffff0000, v19
    v_add_f32 v40, v40, v48
    v_fmac_f32 v42, v48, v48
    v_add_f32 v44, v44, v49
    v_fmac_f32 v45, v49, v49
    v_add_f32 v40, v40, v44
    v_add_f32 v42, v42, v45
    v_mov_b32 v41, s45
    v_mov_b32 v43, s45
    v_add_f32_dpp v40, v40, v40 row_ror:8 row_mask:0xf bank_mask:0xf
    v_add_f32_dpp v42, v42, v42 row_ror:8 row_mask:0xf bank_mask:0xf
    s_nop 0
    v_add_f32_dpp v40, v40, v40 row_ror:4 row_mask:0xf bank_mask:0xf
    v_add_f32_dpp v42, v42, v42 row_ror:4 row_mask:0xf bank_mask:0xf
    s_nop 0
    v_add_f32_dpp v40, v40, v40 row_ror:2 row_mask:0xf bank_mask:0xf
    v_add_f32_dpp v42, v42, v42 row_ror:2 row_mask:0xf bank_mask:0xf
    s_nop 0
    v_add_f32_dpp v40, v40, v40 row_ror:1 row_mask:0xf bank_mask:0xf
    v_add_f32_dpp v42, v42, v42 row_ror:1 row_mask:0xf bank_mask:0xf
    s_lshl_b32 s83, s83, 6
    s_add_u32 s83, s83, 1048576
    s_mov_b32 exec_lo, 0x00010001
    s_mov_b32 exec_hi, 0x00010001
    buffer_store_dwordx4 v[40:43], v253, s[20:23], s83 offen sc1
    s_mov_b64 exec, -1
    s_waitcnt vmcnt(9)
    v_lshlrev_b32 v0, 16, v20
    v_and_b32 v1, 0xffff0000, v20
    v_lshlrev_b32 v2, 16, v21
    v_and_b32 v3, 0xffff0000, v21
    v_lshlrev_b32 v4, 16, v22
    v_and_b32 v5, 0xffff0000, v22
    v_lshlrev_b32 v6, 16, v23
    v_and_b32 v7, 0xffff0000, v23
    v_lshlrev_b32 v8, 16, v24
    v_and_b32 v9, 0xffff0000, v24
    v_add_f32 v0, v0, v8
    v_add_f32 v1, v1, v9
    v_lshlrev_b32 v10, 16, v25
    v_and_b32 v11, 0xffff0000, v25
    v_add_f32 v2, v2, v10
    v_add_f32 v3, v3, v11
    v_lshlrev_b32 v8, 16, v26
    v_and_b32 v9, 0xffff0000, v26
    v_add_f32 v4, v4, v8
    v_add_f32 v5, v5, v9
    v_lshlrev_b32 v10, 16, v27
    v_and_b32 v11, 0xffff0000, v27
    v_add_f32 v6, v6, v10
    v_add_f32 v7, v7, v11
    v_lshlrev_b32 v8, 16, v28
    v_and_b32 v9, 0xffff0000, v28
    v_add_f32 v0, v0, v8
    v_add_f32 v1, v1, v9
    v_lshlrev_b32 v10, 16, v29
    v_and_b32 v11, 0xffff0000, v29
    v_add_f32 v2, v2, v10
    v_add_f32 v3, v3, v11
    v_lshlrev_b32 v8, 16, v30
    v_and_b32 v9, 0xffff0000, v30
    v_add_f32 v4, v4, v8
    v_add_f32 v5, v5, v9
    v_lshlrev_b32 v10, 16, v31
    v_and_b32 v11, 0xffff0000, v31
    v_add_f32 v6, v6, v10
    v_add_f32 v7, v7, v11
    v_lshlrev_b32 v8, 16, v32
    v_and_b32 v9, 0xffff0000, v32
    v_add_f32 v0, v0, v8
    v_add_f32 v1, v1, v9
    v_lshlrev_b32 v10, 16, v33
    v_and_b32 v11, 0xffff0000, v33
    v_add_f32 v2, v2, v10
    v_add_f32 v3, v3, v11
    v_lshlrev_b32 v8, 16, v34
    v_and_b32 v9, 0xffff0000, v34
    v_add_f32 v4, v4, v8
    v_add_f32 v5, v5, v9
    v_lshlrev_b32 v10, 16, v35
    v_and_b32 v11, 0xffff0000, v35
    v_add_f32 v6, v6, v10
    v_add_f32 v7, v7, v11
    v_lshlrev_b32 v8, 16, v36
    v_and_b32 v9, 0xffff0000, v36
    v_add_f32 v0, v0, v8
    v_add_f32 v1, v1, v9
    v_lshlrev_b32 v10, 16, v37
    v_and_b32 v11, 0xffff0000, v37
    v_add_f32 v2, v2, v10
    v_add_f32 v3, v3, v11
    v_lshlrev_b32 v8, 16, v38
    v_and_b32 v9, 0xffff0000, v38
    v_add_f32 v4, v4, v8
    v_add_f32 v5, v5, v9
    v_lshlrev_b32 v10, 16, v39
    v_and_b32 v11, 0xffff0000, v39
    v_add_f32 v6, v6, v10
    v_add_f32 v7, v7, v11
    v_permlane32_swap_b32 v0, v4
    v_permlane32_swap_b32 v1, v5
    v_permlane32_swap_b32 v2, v6
    v_permlane32_swap_b32 v3, v7
    v_add_f32 v0, v0, v4
    v_add_f32 v1, v1, v5
    v_add_f32 v2, v2, v6
    v_add_f32 v3, v3, v7
    s_nop 0
    v_permlane16_swap_b32 v0, v2
    v_permlane16_swap_b32 v1, v3
    v_add_f32 v0, v0, v2
    v_add_f32 v1, v1, v3
    s_nop 0
    v_add_f32_dpp v0, v0, v0 row_ror:8 row_mask:0xf bank_mask:0xf
    v_add_f32_dpp v1, v1, v1 row_ror:8 row_mask:0xf bank_mask:0xf
    v_and_b32 v2, 8, v253
    v_cmp_eq_u32 vcc, 0, v2
    v_lshlrev_b32 v60, 2, v254
    s_nop 0
    v_cndmask_b32 v0, v1, v0, vcc
    ds_write_b32 v60, v0
    s_waitcnt lgkmcnt(0)
    s_barrier
    s_cmp_lg_u32 s6, 0
    s_cbranch_scc1 L_HI_W
    ds_read_b32 v0, v60 offset:0
    ds_read_b32 v1, v60 offset:256
    ds_read_b32 v2, v60 offset:512
    ds_read_b32 v3, v60 offset:768
    ds_read_b32 v4, v60 offset:1024
    ds_read_b32 v5, v60 offset:1280
    ds_read_b32 v6, v60 offset:1536
    ds_read_b32 v7, v60 offset:1792
    v_lshrrev_b32 v61, 3, v253
    v_lshl_add_u32 v61, v64, 3, v61
    v_lshlrev_b32 v61, 4, v61
    s_lshl_b32 s83, s87, 3
    s_and_b32 s84, s85, 1
    s_lshl_b32 s84, s84, 3
    s_add_u32 s83, s83, s84
    s_add_u32 s83, s83, 1081344
    s_waitcnt lgkmcnt(0)
    v_add_f32 v0, v0, v1
    v_add_f32 v2, v2, v3
    v_add_f32 v4, v4, v5
    v_add_f32 v6, v6, v7
    v_add_f32 v0, v0, v2
    v_add_f32 v4, v4, v6
    v_add_f32 v0, v0, v4
    v_mov_b32 v1, s45
    buffer_store_dwordx2 v[0:1], v61, s[20:23], s83 offen sc1
L_HI_W:
    s_waitcnt vmcnt(1)
    s_cmp_ge_u32 s6, 5
    s_cbranch_scc1 L_HT_I
    v_lshlrev_b32 v72, 4, v254
    s_sub_u32 s83, s2, 192
    s_min_u32 s83, s83, 159
    s_mul_i32 s83, s83, 5120
    s_add_u32 s83, s83, 1179648
    buffer_store_dwordx4 v[80:83], v72, s[20:23], s83 offen sc1
    s_sub_u32 s83, s2, 128
    s_min_u32 s83, s83, 159
    s_mul_i32 s83, s83, 5120
    s_add_u32 s83, s83, 1179648
    buffer_store_dwordx4 v[84:87], v72, s[20:23], s83 offen sc1
    s_sub_u32 s83, s2, 64
    s_min_u32 s83, s83, 159
    s_mul_i32 s83, s83, 5120
    s_add_u32 s83, s83, 1179648
    buffer_store_dwordx4 v[88:91], v72, s[20:23], s83 offen sc1
L_HT_I:
    s_mov_b64 s[60:61], s[96:97]
    s_mov_b32 s62, 1966080
    s_mov_b32 s63, 0x20000
    s_sub_u32 s83, s2, 192
    s_mul_i32 s83, s83, 30720
    s_lshl_b32 s84, s6, 12
    s_add_u32 s83, s83, s84
    s_add_u32 m0, s84, 81920
    v_lshlrev_b32 v108, 4, v253
    s_waitcnt lgkmcnt(0)
    buffer_load_dwordx4 v108, s[60:63], s83 offen offset:0 lds
    buffer_load_dwordx4 v108, s[60:63], s83 offen offset:1024 lds
    buffer_load_dwordx4 v108, s[60:63], s83 offen offset:2048 lds
    buffer_load_dwordx4 v108, s[60:63], s83 offen offset:3072 lds
    v_mov_b32 v93, 0
    v_lshlrev_b32 v94, 16, v96
    v_and_b32 v95, 0xffff0000, v96
    v_add_f32 v93, v93, v94
    v_add_f32 v93, v93, v95
    v_lshlrev_b32 v94, 16, v97
    v_and_b32 v95, 0xffff0000, v97
    v_add_f32 v93, v93, v94
    v_add_f32 v93, v93, v95
    v_lshlrev_b32 v94, 16, v98
    v_and_b32 v95, 0xffff0000, v98
    v_add_f32 v93, v93, v94
    v_add_f32 v93, v93, v95
    v_lshlrev_b32 v94, 16, v99
    v_and_b32 v95, 0xffff0000, v99
    v_add_f32 v93, v93, v94
    v_add_f32 v93, v93, v95
    v_lshlrev_b32 v94, 16, v100
    v_and_b32 v95, 0xffff0000, v100
    v_add_f32 v93, v93, v94
    v_add_f32 v93, v93, v95
    s_nop 1
    v_add_f32_dpp v93, v93, v93 row_ror:8 row_mask:0xf bank_mask:0xf
    s_nop 1
    v_add_f32_dpp v93, v93, v93 row_ror:4 row_mask:0xf bank_mask:0xf
    s_nop 1
    v_add_f32_dpp v93, v93, v93 row_ror:2 row_mask:0xf bank_mask:0xf
    s_nop 1
    v_add_f32_dpp v93, v93, v93 row_ror:1 row_mask:0xf bank_mask:0xf
    v_mov_b32 v94, v93
    s_nop 1
    v_permlane16_swap_b32 v93, v94
    v_add_f32 v93, v93, v94
    v_mov_b32 v94, v93
    s_nop 1
    v_permlane32_swap_b32 v93, v94
    v_add_f32 v93, v93, v94
    s_nop 0
    v_readfirstlane_b32 s40, v93
    s_waitcnt vmcnt(4)
    s_barrier
    s_cmp_lg_u32 s6, 7
    s_cbranch_scc1 L_HT_V
    s_sub_u32 s83, s2, 192
    v_lshlrev_b32 v69, 6, v253
    v_add_u32 v69, s83, v69
    v_cmp_gt_u32 vcc, 160, v69
    v_lshlrev_b32 v69, 2, v69
    s_mov_b32 s83, 1116160
    s_mov_b64 exec, vcc
    buffer_store_dword v68, v69, s[20:23], s83 offen sc1
    s_mov_b64 exec, -1
L_HT_V:
    s_waitcnt vmcnt(0)
    s_barrier
    s_mul_i32 s83, s6, 160
    s_add_u32 s83, s83, 81920
    v_add_u32 v9, 0, v253
    v_min_u32 v9, 119, v9
    v_mul_u32_u24 v10, 205, v9
    v_lshrrev_b32 v10, 10, v10
    v_mul_u32_u24 v10, 1200, v10
    v_lshlrev_b32 v11, 4, v9
    v_add3_u32 v6, v10, v11, s83
    v_add_u32 v9, 64, v253
    v_min_u32 v9, 119, v9
    v_mul_u32_u24 v10, 205, v9
    v_lshrrev_b32 v10, 10, v10
    v_mul_u32_u24 v10, 1200, v10
    v_lshlrev_b32 v12, 4, v9
    v_add3_u32 v7, v10, v12, s83
    s_sub_u32 s83, s2, 192
    s_mul_i32 s83, s83, 1920
    s_mul_i32 s84, s6, 245760
    s_add_u32 s83, s83, s84
    s_add_u32 s83, s83, 2097152
    s_add_u32 s84, s83, 122880
    ds_read_b128 v[16:19], v6 offset:0
    ds_read_b128 v[20:23], v7 offset:0
    ds_read_b128 v[24:27], v6 offset:80
    ds_read_b128 v[28:31], v7 offset:80
    s_waitcnt lgkmcnt(0)
    buffer_store_dwordx4 v[16:19], v11, s[20:23], s83 offen sc1
    buffer_store_dwordx4 v[20:23], v12, s[20:23], s83 offen sc1
    buffer_store_dwordx4 v[24:27], v11, s[20:23], s84 offen sc1
    buffer_store_dwordx4 v[28:31], v12, s[20:23], s84 offen sc1
    s_cmp_lg_u32 s3, 0
    s_cbranch_scc1 L_WL_H
    s_mov_b64 s[56:57], s[42:43]
    s_mov_b32 s58, 1280
    s_mov_b32 s59, 0x20000
    s_and_b32 s83, s6, 3
    s_lshl_b32 s84, s38, 2
    s_add_u32 s83, s83, s84
    s_lshl_b32 s83, s83, 4
    v_and_b32 v70, 15, v253
    v_add_u32 v244, s83, v70
    s_mul_i32 s84, s39, 160
    s_lshr_b32 s85, s6, 2
    s_lshl_b32 s85, s85, 6
    s_add_u32 s85, s85, s84
    v_lshrrev_b32 v70, 4, v253
    v_lshlrev_b32 v70, 3, v70
    v_mul_u32_u24 v71, 1280, v244
    v_add_u32 v71, v71, v70
    buffer_load_dwordx2 v[238:239], v71, s[8:11], s85 offen
    buffer_load_dwordx2 v[240:241], v71, s[8:11], s85 offen offset:32
    buffer_load_dwordx2 v[242:243], v71, s[8:11], s84 offen offset:128
    buffer_load_dwordx2 v[232:233], v70, s[56:59], s85 offen
    buffer_load_dwordx2 v[234:235], v70, s[56:59], s85 offen offset:32
    buffer_load_dwordx2 v[236:237], v70, s[56:59], s84 offen offset:128
L_WL_H:
    s_branch L_QKV_END
L_QKV_WORK:
    s_and_b32 s36, s32, 1
    s_lshl_b32 s36, s36, 3
    s_and_b32 s82, s33, 7
    s_add_u32 s36, s36, s82
    s_lshr_b32 s37, s33, 3
    s_lshl_b32 s37, s37, 2
    s_lshr_b32 s82, s32, 1
    s_add_u32 s37, s37, s82
    s_cmp_lt_u32 s6, 4
    s_cbranch_scc1 L_QKV_COMPUTE
    s_setprio 2
    s_and_b32 s83, s6, 1
    s_cmp_ge_u32 s37, 8
    s_cselect_b64 vcc, -1, 0
    s_cselect_b32 s91, 4, 1
    s_cmp_lt_u32 s6, 6
    s_cbranch_scc1 L_QL_W
    s_lshl_b32 s85, s83, 13
    s_lshl_b32 s90, s36, 1
    s_add_u32 s90, s90, s83
    s_lshl_b32 s90, s90, 6
    s_cmp_lg_u32 s3, 0
    s_cbranch_scc1 L_QL_L2
    v_lshrrev_b32 v10, 3, v253
    v_and_b32 v12, 12, v10
    v_add_u32 v12, v12, v10
    v_lshlrev_b32 v11, 1, v10
    v_cndmask_b32 v11, v11, v12, vcc
    v_add_u32 v11, s90, v11
    v_mul_u32_u24 v11, 1280, v11
    v_lshrrev_b32 v10, 1, v10
    v_xor_b32 v10, v10, v253
    v_and_b32 v10, 7, v10
    v_lshl_add_u32 v11, v10, 4, v11
    v_add_u32 v0, 4096, v11
    v_lshrrev_b32 v10, 3, v253
    v_add_u32 v10, 8, v10
    v_and_b32 v12, 12, v10
    v_add_u32 v12, v12, v10
    v_lshlrev_b32 v11, 1, v10
    v_cndmask_b32 v11, v11, v12, vcc
    v_add_u32 v11, s90, v11
    v_mul_u32_u24 v11, 1280, v11
    v_lshrrev_b32 v10, 1, v10
    v_xor_b32 v10, v10, v253
    v_and_b32 v10, 7, v10
    v_lshl_add_u32 v11, v10, 4, v11
    v_add_u32 v1, 3072, v11
    s_mul_i32 s84, s91, 1280
    s_sub_u32 s84, s84, 2048
    v_add_u32 v2, s84, v0
    v_add_u32 v3, s84, v1
    v_add_u32 v4, 40960, v0
    v_add_u32 v5, 40960, v1
    v_add_u32 v6, 40960, v2
    v_add_u32 v7, 40960, v3
    s_waitcnt lgkmcnt(0)
    s_sub_u32 s28, s8, 4096
    s_subb_u32 s29, s9, 0
    s_add_u32 s30, s10, 4096
    s_mov_b32 s88, 128
    s_branch L_QL_XG
L_QL_L2:
    v_bfe_u32 v10, v253, 4, 1
    v_mul_u32_u24 v10, s91, v10
    v_xor_b32 v10, v10, v253
    s_lshr_b32 s90, s90, 4
    s_mul_i32 s90, s90, 20480
    s_add_u32 s90, s90, 12124160
    v_lshlrev_b32 v10, 4, v10
    v_add_u32 v0, s90, v10
    v_mov_b32 v1, v0
    v_add_u32 v2, 18432, v0
    v_mov_b32 v3, v2
    v_add_u32 v4, 40960, v0
    v_mov_b32 v5, v4
    v_add_u32 v6, 59392, v0
    v_mov_b32 v7, v6
    s_mov_b32 s28, s20
    s_mov_b32 s29, s21
    s_mov_b32 s30, s22
    s_mov_b32 s88, 2048
    s_lshl_b32 s90, s36, 4
    s_add_u32 s90, s90, s37
    s_mul_i32 s90, s90, 512
    s_add_u32 s90, s90, 20
    v_lshlrev_b32 v20, 7, v253
    s_mov_b32 exec_lo, 1
    s_mov_b32 exec_hi, 0
    s_mov_b32 s82, 0
POLL_1:
    buffer_load_dword v21, v20, s[20:23], s90 offen sc1
    s_add_u32 s82, s82, 1
    s_cmp_gt_u32 s82, 131072
    s_cbranch_scc1 POLLX_2
    s_waitcnt vmcnt(0)
    v_cmp_ne_u32 vcc, 16, v21
    s_nop 0
    s_cbranch_vccnz POLL_1
POLLX_2:
    s_waitcnt vmcnt(0)
    s_mov_b64 exec, -1
L_QL_XG:
    s_mul_i32 s89, s88, 10
    s_mov_b32 s84, 0
    s_and_b32 s90, s33, 7
    s_mul_i32 s90, s90, 8
    s_lshr_b32 s84, s33, 3
    s_mul_i32 s84, s84, 20
    s_add_u32 s90, s90, s84
    s_mul_i32 s90, s90, 43
    s_lshr_b32 s90, s90, 8
    s_sub_u32 s84, s90, 10
    s_cmp_ge_u32 s90, 10
    s_cmov_b32 s90, s84
    s_cmp_ge_u32 s90, 5
    s_cselect_b32 s90, 5, 0
    s_cmp_lg_u32 s3, 0
    s_cmov_b32 s90, 0
    s_mul_i32 s84, s90, s88
    s_add_u32 m0, s85, 0
    s_nop 0
    buffer_load_dwordx4 v0, s[28:31], s84 offen offset:0 sc1 lds
    buffer_load_dwordx4 v1, s[28:31], s84 offen offset:1024 sc1 lds
    buffer_load_dwordx4 v2, s[28:31], s84 offen offset:2048 sc1 lds
    buffer_load_dwordx4 v3, s[28:31], s84 offen offset:3072 sc1 lds
    s_add_u32 m0, s85, 4096
    s_nop 0
    buffer_load_dwordx4 v4, s[28:31], s84 offen offset:0 sc1 lds
    buffer_load_dwordx4 v5, s[28:31], s84 offen offset:1024 sc1 lds
    buffer_load_dwordx4 v6, s[28:31], s84 offen offset:2048 sc1 lds
    buffer_load_dwordx4 v7, s[28:31], s84 offen offset:3072 sc1 lds
    s_add_u32 s84, s84, s88
    s_cmp_ge_u32 s84, s89
    s_cmov_b32 s84, 0
    s_add_u32 m0, s85, 36864
    s_nop 0
    buffer_load_dwordx4 v0, s[28:31], s84 offen offset:0 sc1 lds
    buffer_load_dwordx4 v1, s[28:31], s84 offen offset:1024 sc1 lds
    buffer_load_dwordx4 v2, s[28:31], s84 offen offset:2048 sc1 lds
    buffer_load_dwordx4 v3, s[28:31], s84 offen offset:3072 sc1 lds
    s_add_u32 m0, s85, 40960
    s_nop 0
    buffer_load_dwordx4 v4, s[28:31], s84 offen offset:0 sc1 lds
    buffer_load_dwordx4 v5, s[28:31], s84 offen offset:1024 sc1 lds
    buffer_load_dwordx4 v6, s[28:31], s84 offen offset:2048 sc1 lds
    buffer_load_dwordx4 v7, s[28:31], s84 offen offset:3072 sc1 lds
    s_add_u32 s84, s84, s88
    s_cmp_ge_u32 s84, s89
    s_cmov_b32 s84, 0
    s_waitcnt vmcnt(8)
    s_barrier
    s_add_u32 m0, s85, 73728
    s_nop 0
    buffer_load_dwordx4 v0, s[28:31], s84 offen offset:0 sc1 lds
    buffer_load_dwordx4 v1, s[28:31], s84 offen offset:1024 sc1 lds
    buffer_load_dwordx4 v2, s[28:31], s84 offen offset:2048 sc1 lds
    buffer_load_dwordx4 v3, s[28:31], s84 offen offset:3072 sc1 lds
    s_add_u32 m0, s85, 77824
    s_nop 0
    buffer_load_dwordx4 v4, s[28:31], s84 offen offset:0 sc1 lds
    buffer_load_dwordx4 v5, s[28:31], s84 offen offset:1024 sc1 lds
    buffer_load_dwordx4 v6, s[28:31], s84 offen offset:2048 sc1 lds
    buffer_load_dwordx4 v7, s[28:31], s84 offen offset:3072 sc1 lds
    s_add_u32 s84, s84, s88
    s_cmp_ge_u32 s84, s89
    s_cmov_b32 s84, 0
    s_add_u32 m0, s85, 110592
    s_nop 0
    buffer_load_dwordx4 v0, s[28:31], s84 offen offset:0 sc1 lds
    buffer_load_dwordx4 v1, s[28:31], s84 offen offset:1024 sc1 lds
    buffer_load_dwordx4 v2, s[28:31], s84 offen offset:2048 sc1 lds
    buffer_load_dwordx4 v3, s[28:31], s84 offen offset:3072 sc1 lds
    s_add_u32 m0, s85, 114688
    s_nop 0
    buffer_load_dwordx4 v4, s[28:31], s84 offen offset:0 sc1 lds
    buffer_load_dwordx4 v5, s[28:31], s84 offen offset:1024 sc1 lds
    buffer_load_dwordx4 v6, s[28:31], s84 offen offset:2048 sc1 lds
    buffer_load_dwordx4 v7, s[28:31], s84 offen offset:3072 sc1 lds
    s_add_u32 s84, s84, s88
    s_cmp_ge_u32 s84, s89
    s_cmov_b32 s84, 0
    s_waitcnt vmcnt(16)
    s_barrier
    s_add_u32 m0, s85, 0
    s_nop 0
    buffer_load_dwordx4 v0, s[28:31], s84 offen offset:0 sc1 lds
    buffer_load_dwordx4 v1, s[28:31], s84 offen offset:1024 sc1 lds
    buffer_load_dwordx4 v2, s[28:31], s84 offen offset:2048 sc1 lds
    buffer_load_dwordx4 v3, s[28:31], s84 offen offset:3072 sc1 lds
    s_add_u32 m0, s85, 4096
    s_nop 0
    buffer_load_dwordx4 v4, s[28:31], s84 offen offset:0 sc1 lds
    buffer_load_dwordx4 v5, s[28:31], s84 offen offset:1024 sc1 lds
    buffer_load_dwordx4 v6, s[28:31], s84 offen offset:2048 sc1 lds
    buffer_load_dwordx4 v7, s[28:31], s84 offen offset:3072 sc1 lds
    s_add_u32 s84, s84, s88
    s_cmp_ge_u32 s84, s89
    s_cmov_b32 s84, 0
    s_waitcnt vmcnt(16)
    s_barrier
    s_add_u32 m0, s85, 36864
    s_nop 0
    buffer_load_dwordx4 v0, s[28:31], s84 offen offset:0 sc1 lds
    buffer_load_dwordx4 v1, s[28:31], s84 offen offset:1024 sc1 lds
    buffer_load_dwordx4 v2, s[28:31], s84 offen offset:2048 sc1 lds
    buffer_load_dwordx4 v3, s[28:31], s84 offen offset:3072 sc1 lds
    s_add_u32 m0, s85, 40960
    s_nop 0
    buffer_load_dwordx4 v4, s[28:31], s84 offen offset:0 sc1 lds
    buffer_load_dwordx4 v5, s[28:31], s84 offen offset:1024 sc1 lds
    buffer_load_dwordx4 v6, s[28:31], s84 offen offset:2048 sc1 lds
    buffer_load_dwordx4 v7, s[28:31], s84 offen offset:3072 sc1 lds
    s_add_u32 s84, s84, s88
    s_cmp_ge_u32 s84, s89
    s_cmov_b32 s84, 0
    s_waitcnt vmcnt(16)
    s_barrier
    s_add_u32 m0, s85, 73728
    s_nop 0
    buffer_load_dwordx4 v0, s[28:31], s84 offen offset:0 sc1 lds
    buffer_load_dwordx4 v1, s[28:31], s84 offen offset:1024 sc1 lds
    buffer_load_dwordx4 v2, s[28:31], s84 offen offset:2048 sc1 lds
    buffer_load_dwordx4 v3, s[28:31], s84 offen offset:3072 sc1 lds
    s_add_u32 m0, s85, 77824
    s_nop 0
    buffer_load_dwordx4 v4, s[28:31], s84 offen offset:0 sc1 lds
    buffer_load_dwordx4 v5, s[28:31], s84 offen offset:1024 sc1 lds
    buffer_load_dwordx4 v6, s[28:31], s84 offen offset:2048 sc1 lds
    buffer_load_dwordx4 v7, s[28:31], s84 offen offset:3072 sc1 lds
    s_add_u32 s84, s84, s88
    s_cmp_ge_u32 s84, s89
    s_cmov_b32 s84, 0
    s_waitcnt vmcnt(16)
    s_barrier
    s_add_u32 m0, s85, 110592
    s_nop 0
    buffer_load_dwordx4 v0, s[28:31], s84 offen offset:0 sc1 lds
    buffer_load_dwordx4 v1, s[28:31], s84 offen offset:1024 sc1 lds
    buffer_load_dwordx4 v2, s[28:31], s84 offen offset:2048 sc1 lds
    buffer_load_dwordx4 v3, s[28:31], s84 offen offset:3072 sc1 lds
    s_add_u32 m0, s85, 114688
    s_nop 0
    buffer_load_dwordx4 v4, s[28:31], s84 offen offset:0 sc1 lds
    buffer_load_dwordx4 v5, s[28:31], s84 offen offset:1024 sc1 lds
    buffer_load_dwordx4 v6, s[28:31], s84 offen offset:2048 sc1 lds
    buffer_load_dwordx4 v7, s[28:31], s84 offen offset:3072 sc1 lds
    s_add_u32 s84, s84, s88
    s_cmp_ge_u32 s84, s89
    s_cmov_b32 s84, 0
    s_waitcnt vmcnt(16)
    s_barrier
    s_add_u32 m0, s85, 0
    s_nop 0
    buffer_load_dwordx4 v0, s[28:31], s84 offen offset:0 sc1 lds
    buffer_load_dwordx4 v1, s[28:31], s84 offen offset:1024 sc1 lds
    buffer_load_dwordx4 v2, s[28:31], s84 offen offset:2048 sc1 lds
    buffer_load_dwordx4 v3, s[28:31], s84 offen offset:3072 sc1 lds
    s_add_u32 m0, s85, 4096
    s_nop 0
    buffer_load_dwordx4 v4, s[28:31], s84 offen offset:0 sc1 lds
    buffer_load_dwordx4 v5, s[28:31], s84 offen offset:1024 sc1 lds
    buffer_load_dwordx4 v6, s[28:31], s84 offen offset:2048 sc1 lds
    buffer_load_dwordx4 v7, s[28:31], s84 offen offset:3072 sc1 lds
    s_add_u32 s84, s84, s88
    s_cmp_ge_u32 s84, s89
    s_cmov_b32 s84, 0
    s_waitcnt vmcnt(16)
    s_barrier
    s_add_u32 m0, s85, 36864
    s_nop 0
    buffer_load_dwordx4 v0, s[28:31], s84 offen offset:0 sc1 lds
    buffer_load_dwordx4 v1, s[28:31], s84 offen offset:1024 sc1 lds
    buffer_load_dwordx4 v2, s[28:31], s84 offen offset:2048 sc1 lds
    buffer_load_dwordx4 v3, s[28:31], s84 offen offset:3072 sc1 lds
    s_add_u32 m0, s85, 40960
    s_nop 0
    buffer_load_dwordx4 v4, s[28:31], s84 offen offset:0 sc1 lds
    buffer_load_dwordx4 v5, s[28:31], s84 offen offset:1024 sc1 lds
    buffer_load_dwordx4 v6, s[28:31], s84 offen offset:2048 sc1 lds
    buffer_load_dwordx4 v7, s[28:31], s84 offen offset:3072 sc1 lds
    s_add_u32 s84, s84, s88
    s_cmp_ge_u32 s84, s89
    s_cmov_b32 s84, 0
    s_waitcnt vmcnt(16)
    s_barrier
    s_waitcnt vmcnt(8)
    s_barrier
    s_waitcnt vmcnt(0)
    s_barrier
    s_cmp_lg_u32 s3, 0
    s_cbranch_scc1 L_WL_X
    s_mov_b64 s[56:57], s[42:43]
    s_mov_b32 s58, 1280
    s_mov_b32 s59, 0x20000
    s_and_b32 s83, s6, 3
    s_lshl_b32 s84, s38, 2
    s_add_u32 s83, s83, s84
    s_lshl_b32 s83, s83, 4
    v_and_b32 v10, 15, v253
    v_add_u32 v244, s83, v10
    s_mul_i32 s84, s39, 160
    s_lshr_b32 s85, s6, 2
    s_lshl_b32 s85, s85, 6
    s_add_u32 s85, s85, s84
    v_lshrrev_b32 v10, 4, v253
    v_lshlrev_b32 v10, 3, v10
    v_mul_u32_u24 v11, 1280, v244
    v_add_u32 v11, v11, v10
    buffer_load_dwordx2 v[238:239], v11, s[8:11], s85 offen
    buffer_load_dwordx2 v[240:241], v11, s[8:11], s85 offen offset:32
    buffer_load_dwordx2 v[242:243], v11, s[8:11], s84 offen offset:128
    buffer_load_dwordx2 v[232:233], v10, s[56:59], s85 offen
    buffer_load_dwordx2 v[234:235], v10, s[56:59], s85 offen offset:32
    buffer_load_dwordx2 v[236:237], v10, s[56:59], s84 offen offset:128
L_WL_X:
    s_barrier
    s_branch L_QKV_END
L_QL_W:
    s_mul_i32 s90, s37, 320
    s_mul_i32 s84, s83, 122880
    s_add_u32 s90, s90, s84
    v_add_u32 v10, 0, v253
    v_mul_u32_u24 v11, 205, v10
    v_lshrrev_b32 v11, 12, v11
    v_mul_u32_u24 v12, 20, v11
    v_sub_u32 v10, v10, v12
    v_lshrrev_b32 v12, 2, v11
    v_and_b32 v12, 2, v12
    v_xor_b32 v10, v10, v12
    v_mul_u32_u24 v11, 3840, v11
    v_lshl_add_u32 v11, v10, 4, v11
    v_add_u32 v11, s90, v11
    v_subrev_u32 v0, 0, v11
    v_add_u32 v5, 60416, v11
    v_add_u32 v10, 64, v253
    v_mul_u32_u24 v11, 205, v10
    v_lshrrev_b32 v11, 12, v11
    v_mul_u32_u24 v12, 20, v11
    v_sub_u32 v10, v10, v12
    v_lshrrev_b32 v12, 2, v11
    v_and_b32 v12, 2, v12
    v_xor_b32 v10, v10, v12
    v_mul_u32_u24 v11, 3840, v11
    v_lshl_add_u32 v11, v10, 4, v11
    v_add_u32 v11, s90, v11
    v_subrev_u32 v1, 1024, v11
    v_add_u32 v6, 59392, v11
    v_add_u32 v10, 128, v253
    v_mul_u32_u24 v11, 205, v10
    v_lshrrev_b32 v11, 12, v11
    v_mul_u32_u24 v12, 20, v11
    v_sub_u32 v10, v10, v12
    v_lshrrev_b32 v12, 2, v11
    v_and_b32 v12, 2, v12
    v_xor_b32 v10, v10, v12
    v_mul_u32_u24 v11, 3840, v11
    v_lshl_add_u32 v11, v10, 4, v11
    v_add_u32 v11, s90, v11
    v_subrev_u32 v2, 2048, v11
    v_add_u32 v7, 58368, v11
    v_add_u32 v10, 192, v253
    v_mul_u32_u24 v11, 205, v10
    v_lshrrev_b32 v11, 12, v11
    v_mul_u32_u24 v12, 20, v11
    v_sub_u32 v10, v10, v12
    v_lshrrev_b32 v12, 2, v11
    v_and_b32 v12, 2, v12
    v_xor_b32 v10, v10, v12
    v_mul_u32_u24 v11, 3840, v11
    v_lshl_add_u32 v11, v10, 4, v11
    v_add_u32 v11, s90, v11
    v_subrev_u32 v3, 3072, v11
    v_add_u32 v8, 61440, v11
    v_add_u32 v10, 256, v253
    v_mul_u32_u24 v11, 205, v10
    v_lshrrev_b32 v11, 12, v11
    v_mul_u32_u24 v12, 20, v11
    v_sub_u32 v10, v10, v12
    v_lshrrev_b32 v12, 2, v11
    v_and_b32 v12, 2, v12
    v_xor_b32 v10, v10, v12
    v_mul_u32_u24 v11, 3840, v11
    v_lshl_add_u32 v11, v10, 4, v11
    v_add_u32 v11, s90, v11
    v_subrev_u32 v4, 0, v11
    v_add_u32 v9, 60416, v11
    s_mov_b32 s88, 245760
    s_mul_i32 s85, s83, 10240
    s_add_u32 s85, s85, 16384
    s_mul_i32 s89, s88, 10
    s_mov_b32 s84, 0
    s_and_b32 s90, s33, 7
    s_mul_i32 s90, s90, 8
    s_lshr_b32 s84, s33, 3
    s_mul_i32 s84, s84, 20
    s_add_u32 s90, s90, s84
    s_mul_i32 s90, s90, 43
    s_lshr_b32 s90, s90, 8
    s_sub_u32 s84, s90, 10
    s_cmp_ge_u32 s90, 10
    s_cmov_b32 s90, s84
    s_cmp_ge_u32 s90, 5
    s_cselect_b32 s90, 5, 0
    s_cmp_lg_u32 s3, 0
    s_cmov_b32 s90, 0
    s_mul_i32 s84, s90, s88
    s_cmp_eq_u32 s3, 0
    s_cbranch_scc1 L_QL_A
    s_add_u32 m0, s85, 0
    s_nop 0
    buffer_load_dwordx4 v0, s[12:15], s84 offen offset:0  lds
    buffer_load_dwordx4 v1, s[12:15], s84 offen offset:1024  lds
    buffer_load_dwordx4 v2, s[12:15], s84 offen offset:2048  lds
    buffer_load_dwordx4 v3, s[12:15], s84 offen offset:3072  lds
    s_add_u32 m0, s85, 4096
    s_nop 0
    buffer_load_dwordx4 v4, s[12:15], s84 offen offset:0  lds
    buffer_load_dwordx4 v5, s[12:15], s84 offen offset:1024  lds
    buffer_load_dwordx4 v6, s[12:15], s84 offen offset:2048  lds
    buffer_load_dwordx4 v7, s[12:15], s84 offen offset:3072  lds
    s_add_u32 m0, s85, 8192
    s_nop 0
    buffer_load_dwordx4 v8, s[12:15], s84 offen offset:0  lds
    buffer_load_dwordx4 v9, s[12:15], s84 offen offset:1024  lds
    s_add_u32 s84, s84, s88
    s_cmp_ge_u32 s84, s89
    s_cmov_b32 s84, 0
    s_add_u32 m0, s85, 36864
    s_nop 0
    buffer_load_dwordx4 v0, s[12:15], s84 offen offset:0  lds
    buffer_load_dwordx4 v1, s[12:15], s84 offen offset:1024  lds
    buffer_load_dwordx4 v2, s[12:15], s84 offen offset:2048  lds
    buffer_load_dwordx4 v3, s[12:15], s84 offen offset:3072  lds
    s_add_u32 m0, s85, 40960
    s_nop 0
    buffer_load_dwordx4 v4, s[12:15], s84 offen offset:0  lds
    buffer_load_dwordx4 v5, s[12:15], s84 offen offset:1024  lds
    buffer_load_dwordx4 v6, s[12:15], s84 offen offset:2048  lds
    buffer_load_dwordx4 v7, s[12:15], s84 offen offset:3072  lds
    s_add_u32 m0, s85, 45056
    s_nop 0
    buffer_load_dwordx4 v8, s[12:15], s84 offen offset:0  lds
    buffer_load_dwordx4 v9, s[12:15], s84 offen offset:1024  lds
    s_add_u32 s84, s84, s88
    s_cmp_ge_u32 s84, s89
    s_cmov_b32 s84, 0
    s_add_u32 m0, s85, 73728
    s_nop 0
    buffer_load_dwordx4 v0, s[12:15], s84 offen offset:0  lds
    buffer_load_dwordx4 v1, s[12:15], s84 offen offset:1024  lds
    buffer_load_dwordx4 v2, s[12:15], s84 offen offset:2048  lds
    buffer_load_dwordx4 v3, s[12:15], s84 offen offset:3072  lds
    s_add_u32 m0, s85, 77824
    s_nop 0
    buffer_load_dwordx4 v4, s[12:15], s84 offen offset:0  lds
    buffer_load_dwordx4 v5, s[12:15], s84 offen offset:1024  lds
    buffer_load_dwordx4 v6, s[12:15], s84 offen offset:2048  lds
    buffer_load_dwordx4 v7, s[12:15], s84 offen offset:3072  lds
    s_add_u32 m0, s85, 81920
    s_nop 0
    buffer_load_dwordx4 v8, s[12:15], s84 offen offset:0  lds
    buffer_load_dwordx4 v9, s[12:15], s84 offen offset:1024  lds
    s_add_u32 s84, s84, s88
    s_cmp_ge_u32 s84, s89
    s_cmov_b32 s84, 0
    s_waitcnt vmcnt(20)
    s_barrier
    s_add_u32 m0, s85, 110592
    s_nop 0
    buffer_load_dwordx4 v0, s[12:15], s84 offen offset:0  lds
    buffer_load_dwordx4 v1, s[12:15], s84 offen offset:1024  lds
    buffer_load_dwordx4 v2, s[12:15], s84 offen offset:2048  lds
    buffer_load_dwordx4 v3, s[12:15], s84 offen offset:3072  lds
    s_add_u32 m0, s85, 114688
    s_nop 0
    buffer_load_dwordx4 v4, s[12:15], s84 offen offset:0  lds
    buffer_load_dwordx4 v5, s[12:15], s84 offen offset:1024  lds
    buffer_load_dwordx4 v6, s[12:15], s84 offen offset:2048  lds
    buffer_load_dwordx4 v7, s[12:15], s84 offen offset:3072  lds
    s_add_u32 m0, s85, 118784
    s_nop 0
    buffer_load_dwordx4 v8, s[12:15], s84 offen offset:0  lds
    buffer_load_dwordx4 v9, s[12:15], s84 offen offset:1024  lds
    s_add_u32 s84, s84, s88
    s_cmp_ge_u32 s84, s89
    s_cmov_b32 s84, 0
    s_waitcnt vmcnt(20)
    s_barrier
    s_branch L_QL_B
L_QL_A:
    s_waitcnt lgkmcnt(0)
    s_add_u32 m0, s85, 0
    s_nop 0
    buffer_load_dwordx4 v0, s[12:15], s84 offen offset:0  lds
    buffer_load_dwordx4 v1, s[12:15], s84 offen offset:1024  lds
    buffer_load_dwordx4 v2, s[12:15], s84 offen offset:2048  lds
    buffer_load_dwordx4 v3, s[12:15], s84 offen offset:3072  lds
    s_add_u32 m0, s85, 4096
    s_nop 0
    buffer_load_dwordx4 v4, s[12:15], s84 offen offset:0  lds
    buffer_load_dwordx4 v5, s[12:15], s84 offen offset:1024  lds
    buffer_load_dwordx4 v6, s[12:15], s84 offen offset:2048  lds
    buffer_load_dwordx4 v7, s[12:15], s84 offen offset:3072  lds
    s_add_u32 m0, s85, 8192
    s_nop 0
    buffer_load_dwordx4 v8, s[12:15], s84 offen offset:0  lds
    buffer_load_dwordx4 v9, s[12:15], s84 offen offset:1024  lds
    s_add_u32 s84, s84, s88
    s_cmp_ge_u32 s84, s89
    s_cmov_b32 s84, 0
    s_mov_b32 s82, 1114048
    s_load_dword s45, s[20:21], s82
    s_add_u32 m0, s85, 36864
    s_nop 0
    buffer_load_dwordx4 v0, s[12:15], s84 offen offset:0  lds
    buffer_load_dwordx4 v1, s[12:15], s84 offen offset:1024  lds
    buffer_load_dwordx4 v2, s[12:15], s84 offen offset:2048  lds
    buffer_load_dwordx4 v3, s[12:15], s84 offen offset:3072  lds
    s_add_u32 m0, s85, 40960
    s_nop 0
    buffer_load_dwordx4 v4, s[12:15], s84 offen offset:0  lds
    buffer_load_dwordx4 v5, s[12:15], s84 offen offset:1024  lds
    buffer_load_dwordx4 v6, s[12:15], s84 offen offset:2048  lds
    buffer_load_dwordx4 v7, s[12:15], s84 offen offset:3072  lds
    s_add_u32 m0, s85, 45056
    s_nop 0
    buffer_load_dwordx4 v8, s[12:15], s84 offen offset:0  lds
    buffer_load_dwordx4 v9, s[12:15], s84 offen offset:1024  lds
    s_add_u32 s84, s84, s88
    s_cmp_ge_u32 s84, s89
    s_cmov_b32 s84, 0
    s_waitcnt lgkmcnt(0)
    s_mul_i32 s45, s45, 0x9e3779b1
    s_add_u32 s45, s45, 0x7f4a7c15
    s_waitcnt vmcnt(10)
    s_barrier
    s_add_u32 m0, s85, 73728
    s_nop 0
    buffer_load_dwordx4 v0, s[12:15], s84 offen offset:0  lds
    buffer_load_dwordx4 v1, s[12:15], s84 offen offset:1024  lds
    buffer_load_dwordx4 v2, s[12:15], s84 offen offset:2048  lds
    buffer_load_dwordx4 v3, s[12:15], s84 offen offset:3072  lds
    s_add_u32 m0, s85, 77824
    s_nop 0
    buffer_load_dwordx4 v4, s[12:15], s84 offen offset:0  lds
    buffer_load_dwordx4 v5, s[12:15], s84 offen offset:1024  lds
    buffer_load_dwordx4 v6, s[12:15], s84 offen offset:2048  lds
    buffer_load_dwordx4 v7, s[12:15], s84 offen offset:3072  lds
    s_add_u32 m0, s85, 81920
    s_nop 0
    buffer_load_dwordx4 v8, s[12:15], s84 offen offset:0  lds
    buffer_load_dwordx4 v9, s[12:15], s84 offen offset:1024  lds
    s_add_u32 s84, s84, s88
    s_cmp_ge_u32 s84, s89
    s_cmov_b32 s84, 0
    s_add_u32 m0, s85, 110592
    s_nop 0
    buffer_load_dwordx4 v0, s[12:15], s84 offen offset:0  lds
    buffer_load_dwordx4 v1, s[12:15], s84 offen offset:1024  lds
    buffer_load_dwordx4 v2, s[12:15], s84 offen offset:2048  lds
    buffer_load_dwordx4 v3, s[12:15], s84 offen offset:3072  lds
    s_add_u32 m0, s85, 114688
    s_nop 0
    buffer_load_dwordx4 v4, s[12:15], s84 offen offset:0  lds
    buffer_load_dwordx4 v5, s[12:15], s84 offen offset:1024  lds
    buffer_load_dwordx4 v6, s[12:15], s84 offen offset:2048  lds
    buffer_load_dwordx4 v7, s[12:15], s84 offen offset:3072  lds
    s_add_u32 m0, s85, 118784
    s_nop 0
    buffer_load_dwordx4 v8, s[12:15], s84 offen offset:0  lds
    buffer_load_dwordx4 v9, s[12:15], s84 offen offset:1024  lds
    s_add_u32 s84, s84, s88
    s_cmp_ge_u32 s84, s89
    s_cmov_b32 s84, 0
    s_waitcnt vmcnt(20)
    s_barrier
L_QL_B:
    v_and_b32 v16, 15, v253
    v_and_b32 v18, 12, v16
    v_add_u32 v18, v18, v16
    v_lshlrev_b32 v17, 1, v16
    v_cndmask_b32 v17, v17, v18, vcc
    v_bfe_u32 v16, v253, 4, 1
    v_mul_u32_u24 v16, s91, v16
    v_add_u32 v17, v17, v16
    v_and_b32 v16, 32, v253
    v_add_u32 v17, v17, v16
    s_lshl_b32 s90, s36, 1
    s_add_u32 s90, s90, s83
    s_lshl_b32 s90, s90, 6
    v_add_u32 v17, s90, v17
    v_lshlrev_b32 v17, 4, v17
    v_mov_b32 v16, 0
    v_lshlrev_b32 v19, 4, v253
    s_mov_b32 s86, 1048576
    s_cmp_lg_u32 s3, 0
    s_cmov_b32 s86, 131072
    s_lshl_b32 s87, s37, 1
    s_add_u32 s87, s87, s83
    s_mul_i32 s87, s87, 1280
    s_add_u32 s87, s87, 1081344
    v_and_b32 v31, 0xf0, v19
    s_add_u32 m0, s85, 0
    s_nop 0
    buffer_load_dwordx4 v0, s[12:15], s84 offen offset:0  lds
    buffer_load_dwordx4 v1, s[12:15], s84 offen offset:1024  lds
    buffer_load_dwordx4 v2, s[12:15], s84 offen offset:2048  lds
    buffer_load_dwordx4 v3, s[12:15], s84 offen offset:3072  lds
    s_add_u32 m0, s85, 4096
    s_nop 0
    buffer_load_dwordx4 v4, s[12:15], s84 offen offset:0  lds
    buffer_load_dwordx4 v5, s[12:15], s84 offen offset:1024  lds
    buffer_load_dwordx4 v6, s[12:15], s84 offen offset:2048  lds
    buffer_load_dwordx4 v7, s[12:15], s84 offen offset:3072  lds
    s_add_u32 m0, s85, 8192
    s_nop 0
    buffer_load_dwordx4 v8, s[12:15], s84 offen offset:0  lds
    buffer_load_dwordx4 v9, s[12:15], s84 offen offset:1024  lds
    s_add_u32 s84, s84, s88
    s_cmp_ge_u32 s84, s89
    s_cmov_b32 s84, 0
    s_waitcnt vmcnt(20)
    s_barrier
    s_add_u32 m0, s85, 36864
    s_nop 0
    buffer_load_dwordx4 v0, s[12:15], s84 offen offset:0  lds
    buffer_load_dwordx4 v1, s[12:15], s84 offen offset:1024  lds
    buffer_load_dwordx4 v2, s[12:15], s84 offen offset:2048  lds
    buffer_load_dwordx4 v3, s[12:15], s84 offen offset:3072  lds
    s_add_u32 m0, s85, 40960
    s_nop 0
    buffer_load_dwordx4 v4, s[12:15], s84 offen offset:0  lds
    buffer_load_dwordx4 v5, s[12:15], s84 offen offset:1024  lds
    buffer_load_dwordx4 v6, s[12:15], s84 offen offset:2048  lds
    buffer_load_dwordx4 v7, s[12:15], s84 offen offset:3072  lds
    s_add_u32 m0, s85, 45056
    s_nop 0
    buffer_load_dwordx4 v8, s[12:15], s84 offen offset:0  lds
    buffer_load_dwordx4 v9, s[12:15], s84 offen offset:1024  lds
    s_add_u32 s84, s84, s88
    s_cmp_ge_u32 s84, s89
    s_cmov_b32 s84, 0
    s_waitcnt vmcnt(20)
    s_barrier
    s_add_u32 m0, s85, 73728
    s_nop 0
    buffer_load_dwordx4 v0, s[12:15], s84 offen offset:0  lds
    buffer_load_dwordx4 v1, s[12:15], s84 offen offset:1024  lds
    buffer_load_dwordx4 v2, s[12:15], s84 offen offset:2048  lds
    buffer_load_dwordx4 v3, s[12:15], s84 offen offset:3072  lds
    s_add_u32 m0, s85, 77824
    s_nop 0
    buffer_load_dwordx4 v4, s[12:15], s84 offen offset:0  lds
    buffer_load_dwordx4 v5, s[12:15], s84 offen offset:1024  lds
    buffer_load_dwordx4 v6, s[12:15], s84 offen offset:2048  lds
    buffer_load_dwordx4 v7, s[12:15], s84 offen offset:3072  lds
    s_add_u32 m0, s85, 81920
    s_nop 0
    buffer_load_dwordx4 v8, s[12:15], s84 offen offset:0  lds
    buffer_load_dwordx4 v9, s[12:15], s84 offen offset:1024  lds
    s_add_u32 s84, s84, s88
    s_cmp_ge_u32 s84, s89
    s_cmov_b32 s84, 0
    s_waitcnt vmcnt(20)
    s_barrier
    s_add_u32 m0, s85, 110592
    s_nop 0
    buffer_load_dwordx4 v0, s[12:15], s84 offen offset:0  lds
    buffer_load_dwordx4 v1, s[12:15], s84 offen offset:1024  lds
    buffer_load_dwordx4 v2, s[12:15], s84 offen offset:2048  lds
    buffer_load_dwordx4 v3, s[12:15], s84 offen offset:3072  lds
    s_add_u32 m0, s85, 114688
    s_nop 0
    buffer_load_dwordx4 v4, s[12:15], s84 offen offset:0  lds
    buffer_load_dwordx4 v5, s[12:15], s84 offen offset:1024  lds
    buffer_load_dwordx4 v6, s[12:15], s84 offen offset:2048  lds
    buffer_load_dwordx4 v7, s[12:15], s84 offen offset:3072  lds
    s_add_u32 m0, s85, 118784
    s_nop 0
    buffer_load_dwordx4 v8, s[12:15], s84 offen offset:0  lds
    buffer_load_dwordx4 v9, s[12:15], s84 offen offset:1024  lds
    s_add_u32 s84, s84, s88
    s_cmp_ge_u32 s84, s89
    s_cmov_b32 s84, 0
    s_waitcnt vmcnt(20)
    s_barrier
    buffer_load_dwordx4 v[36:39], v17, s[20:23], s86 offen sc1
    buffer_load_dwordx4 v[40:43], v19, s[20:23], s87 offen sc1
    buffer_load_dwordx4 v[44:47], v31, s[20:23], s87 offen offset:1024 sc1
    s_add_u32 m0, s85, 0
    s_nop 0
    buffer_load_dwordx4 v0, s[12:15], s84 offen offset:0  lds
    buffer_load_dwordx4 v1, s[12:15], s84 offen offset:1024  lds
    buffer_load_dwordx4 v2, s[12:15], s84 offen offset:2048  lds
    buffer_load_dwordx4 v3, s[12:15], s84 offen offset:3072  lds
    s_add_u32 m0, s85, 4096
    s_nop 0
    buffer_load_dwordx4 v4, s[12:15], s84 offen offset:0  lds
    buffer_load_dwordx4 v5, s[12:15], s84 offen offset:1024  lds
    buffer_load_dwordx4 v6, s[12:15], s84 offen offset:2048  lds
    buffer_load_dwordx4 v7, s[12:15], s84 offen offset:3072  lds
    s_add_u32 m0, s85, 8192
    s_nop 0
    buffer_load_dwordx4 v8, s[12:15], s84 offen offset:0  lds
    buffer_load_dwordx4 v9, s[12:15], s84 offen offset:1024  lds
    s_add_u32 s84, s84, s88
    s_cmp_ge_u32 s84, s89
    s_cmov_b32 s84, 0
    s_waitcnt vmcnt(20)
    s_barrier
    s_add_u32 m0, s85, 36864
    s_nop 0
    buffer_load_dwordx4 v0, s[12:15], s84 offen offset:0  lds
    buffer_load_dwordx4 v1, s[12:15], s84 offen offset:1024  lds
    buffer_load_dwordx4 v2, s[12:15], s84 offen offset:2048  lds
    buffer_load_dwordx4 v3, s[12:15], s84 offen offset:3072  lds
    s_add_u32 m0, s85, 40960
    s_nop 0
    buffer_load_dwordx4 v4, s[12:15], s84 offen offset:0  lds
    buffer_load_dwordx4 v5, s[12:15], s84 offen offset:1024  lds
    buffer_load_dwordx4 v6, s[12:15], s84 offen offset:2048  lds
    buffer_load_dwordx4 v7, s[12:15], s84 offen offset:3072  lds
    s_add_u32 m0, s85, 45056
    s_nop 0
    buffer_load_dwordx4 v8, s[12:15], s84 offen offset:0  lds
    buffer_load_dwordx4 v9, s[12:15], s84 offen offset:1024  lds
    s_add_u32 s84, s84, s88
    s_cmp_ge_u32 s84, s89
    s_cmov_b32 s84, 0
    s_waitcnt vmcnt(20)
    s_barrier
    v_mov_b32 v18, s45
    s_cmp_lg_u32 s6, 4
    s_cbranch_scc1 L_QL_F0
    s_cmp_lg_u32 s3, 0
    s_cbranch_scc1 L_QL_F0
    v_lshlrev_b32 v16, 2, v253
    s_mov_b32 s90, 1114112
    buffer_load_dword v18, v16, s[20:23], s90 offen sc1
L_QL_F0:
    s_mov_b32 s82, 0
L_QL_CK:
    v_xor_b32 v20, s45, v41
    v_xor_b32 v21, s45, v43
    v_or_b32 v20, v20, v21
    v_xor_b32 v21, s45, v45
    v_or_b32 v20, v20, v21
    v_xor_b32 v21, s45, v47
    v_or_b32 v20, v20, v21
    s_cmp_lg_u32 s3, 0
    s_cbranch_scc1 L_QL_CK2
    v_xor_b32 v21, s45, v37
    v_or_b32 v20, v20, v21
    v_xor_b32 v21, s45, v39
    v_or_b32 v20, v20, v21
    v_mov_b32 v37, v38
    s_branch L_QL_CK3
L_QL_CK2:
    v_xor_b32 v21, 0x42000000, v39
    v_or_b32 v20, v20, v21
L_QL_CK3:
    v_cmp_ne_u32 vcc, 0, v20
    s_nop 0
    s_cbranch_vccz L_QL_OK
    s_add_u32 s82, s82, 1
    s_cmp_gt_u32 s82, 131072
    s_cbranch_scc1 L_QL_OK
    buffer_load_dwordx4 v[36:39], v17, s[20:23], s86 offen sc1
    buffer_load_dwordx4 v[40:43], v19, s[20:23], s87 offen sc1
    buffer_load_dwordx4 v[44:47], v31, s[20:23], s87 offen offset:1024 sc1
    s_waitcnt vmcnt(0)
    s_branch L_QL_CK
L_QL_OK:
    s_mul_i32 s90, s83, 640
    s_add_u32 s90, s90, 148992
    v_lshl_add_u32 v20, v253, 3, s90
    v_lshrrev_b32 v21, 1, v31
    v_add_u32 v21, s90, v21
    v_add_f32 v40, v40, v42
    v_cvt_pk_bf16_f32 v41, v40, v40
    v_and_b32 v41, 0xffff0000, v41
    v_sub_f32 v41, v40, v41
    v_cvt_pk_bf16_f32 v42, v40, v41
    v_mov_b32 v43, v42
    ds_write_b64 v20, v[42:43] offset:0
    v_add_f32 v44, v44, v46
    v_cvt_pk_bf16_f32 v45, v44, v44
    v_and_b32 v45, 0xffff0000, v45
    v_sub_f32 v45, v44, v45
    v_cvt_pk_bf16_f32 v46, v44, v45
    v_mov_b32 v47, v46
    ds_write_b64 v21, v[46:47] offset:512
    s_waitcnt vmcnt(10)
    s_barrier
    v_mul_f32 v22, 0x3acccccd, v36
    v_mul_f32 v23, 0x3acccccd, v37
    v_fma_f32 v23, -v22, v22, v23
    v_max_f32 v23, 0, v23
    v_cvt_pk_bf16_f32 v24, v22, v22
    v_and_b32 v24, 0xffff0000, v24
    v_cvt_pk_bf16_f32 v26, v23, v23
    v_and_b32 v26, 0xffff0000, v26
    v_add_f32 v26, 0x3727c5ac, v26
    v_cvt_pk_bf16_f32 v26, v26, v26
    v_and_b32 v26, 0xffff0000, v26
    v_sqrt_f32 v25, v26
    s_nop 0
    v_cvt_pk_bf16_f32 v25, v25, v25
    v_and_b32 v25, 0xffff0000, v25
    v_rcp_f32 v25, v25
    s_cmp_lt_u32 s37, 4
    s_cselect_b32 s90, 0x3ea52b5c, 1.0
    s_cmp_lg_u32 s3, 0
    s_cbranch_scc1 L_QL_S2
    v_mov_b32 v22, v24
    v_mul_f32 v30, s90, v25
    s_branch L_QL_S3
L_QL_S2:
    v_sub_f32 v26, v22, v24
    v_add_f32 v27, 1.0, v25
    v_fma_f32 v22, v26, v25, v22
    v_mul_f32 v23, v23, v27
    v_mul_f32 v23, v23, v27
    v_cvt_pk_bf16_f32 v22, v22, v22
    v_and_b32 v22, 0xffff0000, v22
    v_cvt_pk_bf16_f32 v23, v23, v23
    v_and_b32 v23, 0xffff0000, v23
    v_add_f32 v23, 0x3727c5ac, v23
    v_cvt_pk_bf16_f32 v23, v23, v23
    v_and_b32 v23, 0xffff0000, v23
    v_sqrt_f32 v23, v23
    v_fma_f32 v22, v24, v25, v22
    v_rcp_f32 v26, v27
    v_cvt_pk_bf16_f32 v23, v23, v23
    v_and_b32 v23, 0xffff0000, v23
    v_mul_f32 v22, v22, v26
    v_rcp_f32 v23, v23
    v_mul_f32 v27, s90, v27
    v_mul_f32 v30, v27, v23
L_QL_S3:
    v_cvt_pk_bf16_f32 v28, -v22, -v22
    v_and_b32 v26, 0xffff0000, v28
    v_add_f32 v26, v26, v22
    v_cvt_pk_bf16_f32 v29, -v26, -v26
    s_lshl_b32 s90, s83, 8
    s_add_u32 s90, s90, 73728
    v_lshlrev_b32 v26, 2, v253
    v_add_u32 v26, s90, v26
    v_lshlrev_b32 v27, 1, v26
    v_add_u32 v26, 74752, v26
    ds_write_b64 v27, v[28:29]
    ds_write_b32 v26, v30
    s_waitcnt vmcnt(0) lgkmcnt(0)
    s_barrier
    v_cmp_ne_u32 vcc, s45, v18
    s_nop 0
    s_cbranch_vccz L_QL_F
    s_mov_b32 s90, 1114112
    v_min_u32 v20, 63, v253
    v_lshlrev_b32 v20, 2, v20
    s_mov_b32 s82, 0
WI_3:
    buffer_load_dword v21, v20, s[20:23], s90 offen sc1
    s_add_u32 s82, s82, 1
    s_cmp_gt_u32 s82, 131072
    s_cbranch_scc1 WIX_4
    s_waitcnt vmcnt(0)
    v_cmp_ne_u32 vcc, s45, v21
    s_nop 0
    s_cbranch_vccz WIX_4
    s_sleep 8
    s_branch WI_3
WIX_4:
    s_waitcnt vmcnt(0)
L_QL_F:
    s_cmp_lg_u32 s3, 0
    s_cbranch_scc1 L_WL_W
    s_mov_b64 s[56:57], s[42:43]
    s_mov_b32 s58, 1280
    s_mov_b32 s59, 0x20000
    s_and_b32 s83, s6, 3
    s_lshl_b32 s84, s38, 2
    s_add_u32 s83, s83, s84
    s_lshl_b32 s83, s83, 4
    v_and_b32 v10, 15, v253
    v_add_u32 v244, s83, v10
    s_mul_i32 s84, s39, 160
    s_lshr_b32 s85, s6, 2
    s_lshl_b32 s85, s85, 6
    s_add_u32 s85, s85, s84
    v_lshrrev_b32 v10, 4, v253
    v_lshlrev_b32 v10, 3, v10
    v_mul_u32_u24 v11, 1280, v244
    v_add_u32 v11, v11, v10
    buffer_load_dwordx2 v[238:239], v11, s[8:11], s85 offen
    buffer_load_dwordx2 v[240:241], v11, s[8:11], s85 offen offset:32
    buffer_load_dwordx2 v[242:243], v11, s[8:11], s84 offen offset:128
    buffer_load_dwordx2 v[232:233], v10, s[56:59], s85 offen
    buffer_load_dwordx2 v[234:235], v10, s[56:59], s85 offen offset:32
    buffer_load_dwordx2 v[236:237], v10, s[56:59], s84 offen offset:128
L_WL_W:
    s_and_b32 s90, s37, 3
    s_lshl_b32 s90, s90, 6
    s_lshr_b32 s84, s36, 1
    s_add_u32 s90, s90, s84
    v_and_b32 v10, 7, v253
    v_lshrrev_b32 v11, 3, v253
    v_lshl_add_u32 v10, v10, 3, v11
    v_add_u32 v10, s90, v10
    v_mul_u32_u24 v10, 512, v10
    v_mov_b32 v11, 1
    s_cmp_eq_u32 s84, 7
    s_cselect_b32 s86, 0xff, -1
    s_and_b32 s86, s86, 0xffff
    s_lshr_b32 s84, s37, 2
    s_lshl_b32 s84, s84, 31
    s_lshl_b32 s84, s84, 1
    s_add_u32 s84, s84, s34
    s_add_u32 s84, s84, 0
    s_barrier
    s_cmp_lg_u32 s6, 4
    s_cbranch_scc1 L_QKV_END
    s_mov_b32 exec_lo, s86
    s_mov_b32 exec_hi, 0
    buffer_atomic_add v11, v10, s[20:23], s84 offen
    s_mov_b64 exec, -1
    s_branch L_QKV_END
L_QKV_COMPUTE:
    v_mov_b32 v0, 0
    v_mov_b32 v1, 0
    v_mov_b32 v2, 0
    v_mov_b32 v3, 0
    v_mov_b32 v4, 0
    v_mov_b32 v5, 0
    v_mov_b32 v6, 0
    v_mov_b32 v7, 0
    v_mov_b32 v8, 0
    v_mov_b32 v9, 0
    v_mov_b32 v10, 0
    v_mov_b32 v11, 0
    v_mov_b32 v12, 0
    v_mov_b32 v13, 0
    v_mov_b32 v14, 0
    v_mov_b32 v15, 0
    v_mov_b32 v16, 0
    v_mov_b32 v17, 0
    v_mov_b32 v18, 0
    v_mov_b32 v19, 0
    v_mov_b32 v20, 0
    v_mov_b32 v21, 0
    v_mov_b32 v22, 0
    v_mov_b32 v23, 0
    v_mov_b32 v24, 0
    v_mov_b32 v25, 0
    v_mov_b32 v26, 0
    v_mov_b32 v27, 0
    v_mov_b32 v28, 0
    v_mov_b32 v29, 0
    v_mov_b32 v30, 0
    v_mov_b32 v31, 0
    v_mov_b32 v32, 0
    v_mov_b32 v33, 0
    v_mov_b32 v34, 0
    v_mov_b32 v35, 0
    v_mov_b32 v36, 0
    v_mov_b32 v37, 0
    v_mov_b32 v38, 0
    v_mov_b32 v39, 0
    v_mov_b32 v40, 0
    v_mov_b32 v41, 0
    v_mov_b32 v42, 0
    v_mov_b32 v43, 0
    v_mov_b32 v44, 0
    v_mov_b32 v45, 0
    v_mov_b32 v46, 0
    v_mov_b32 v47, 0
    v_mov_b32 v48, 0
    v_mov_b32 v49, 0
    v_mov_b32 v50, 0
    v_mov_b32 v51, 0
    v_mov_b32 v52, 0
    v_mov_b32 v53, 0
    v_mov_b32 v54, 0
    v_mov_b32 v55, 0
    v_mov_b32 v56, 0
    v_mov_b32 v57, 0
    v_mov_b32 v58, 0
    v_mov_b32 v59, 0
    v_mov_b32 v60, 0
    v_mov_b32 v61, 0
    v_mov_b32 v62, 0
    v_mov_b32 v63, 0
    v_mov_b32 v64, 0
    v_mov_b32 v65, 0
    v_mov_b32 v66, 0
    v_mov_b32 v67, 0
    v_mov_b32 v68, 0
    v_mov_b32 v69, 0
    v_mov_b32 v70, 0
    v_mov_b32 v71, 0
    v_mov_b32 v72, 0
    v_mov_b32 v73, 0
    v_mov_b32 v74, 0
    v_mov_b32 v75, 0
    v_mov_b32 v76, 0
    v_mov_b32 v77, 0
    v_mov_b32 v78, 0
    v_mov_b32 v79, 0
    s_lshr_b32 s88, s6, 1
    s_and_b32 s89, s6, 1
    v_and_b32 v158, 15, v253
    v_lshrrev_b32 v159, 4, v253
    v_bfe_u32 v160, v253, 2, 2
    v_lshl_add_u32 v160, v159, 3, v160
    v_mul_u32_u24 v160, 320, v160
    v_and_b32 v161, 3, v253
    v_lshl_add_u32 v160, v161, 3, v160
    s_mul_i32 s90, s89, 160
    s_add_u32 s90, s90, 16384
    v_add_u32 v160, s90, v160
    v_and_b32 v161, 1, v159
    s_cmp_eq_u32 s89, 0
    s_cselect_b32 s90, 32, -32
    v_mul_lo_u32 v161, v161, s90
    v_add_u32 v156, v160, v161
    v_sub_u32 v157, v160, v161
    s_lshl_b32 s90, s88, 13
    s_mov_b32 s91, 0
    s_cmp_lg_u32 s3, 0
    s_cbranch_scc1 L_QC_L2
    v_lshlrev_b32 v160, 7, v158
    v_add_u32 v160, s90, v160
    v_lshrrev_b32 v161, 1, v158
    v_xor_b32 v161, v161, v159
    v_lshl_add_u32 v152, v161, 4, v160
    v_xor_b32 v153, 64, v152
    v_add_u32 v154, 2048, v152
    v_add_u32 v155, 2048, v153
    s_waitcnt lgkmcnt(0)
    s_cmp_lg_u32 s6, 0
    s_cbranch_scc1 L_QC_T
    s_mov_b32 s82, 1114048
    s_load_dword s45, s[20:21], s82
    s_waitcnt lgkmcnt(0)
    s_mul_i32 s45, s45, 0x9e3779b1
    s_add_u32 s45, s45, 0x7f4a7c15
L_QC_T:
    s_branch L_QC_GO
L_QC_L2:
    s_cmp_ge_u32 s37, 8
    s_cselect_b64 vcc, -1, 0
    s_cselect_b32 s92, 64, 16
    v_and_b32 v161, 12, v158
    v_add_u32 v161, v161, v158
    v_lshlrev_b32 v160, 1, v158
    v_cndmask_b32 v160, v160, v161, vcc
    v_lshrrev_b32 v161, 4, v160
    v_lshlrev_b32 v161, 11, v161
    v_and_b32 v160, 15, v160
    v_lshl_add_u32 v161, v160, 4, v161
    v_and_b32 v160, 1, v159
    v_mul_u32_u24 v160, s92, v160
    v_xor_b32 v161, v161, v160
    v_lshl_add_u32 v161, v159, 8, v161
    v_add_u32 v152, s90, v161
    v_add_u32 v153, 1024, v152
    v_xor_b32 v154, s92, v152
    v_xor_b32 v155, s92, v153
L_QC_GO:
    s_cmp_ge_u32 s37, 8
    s_cbranch_scc1 L_QC_V
    v_lshlrev_b32 v160, 14, v159
    v_lshl_add_u32 v160, v158, 4, v160
    s_lshl_b32 s92, s37, 1
    s_add_u32 s92, s92, s89
    s_mul_i32 s92, s92, 327680
    s_lshl_b32 s90, s36, 1
    s_add_u32 s90, s90, s88
    s_lshl_b32 s90, s90, 9
    s_add_u32 s92, s92, s90
    s_add_u32 s92, s92, s7
    s_add_u32 s92, s92, 65536
    s_lshl_b32 s90, s88, 9
    s_add_u32 s90, s90, 147456
    v_lshl_add_u32 v162, v158, 3, s90
    s_mul_i32 s83, s89, 640
    s_add_u32 s83, s83, 148992
    v_lshl_add_u32 v163, v158, 3, s83
    s_lshl_b32 s90, s88, 8
    s_add_u32 s90, s90, 148480
    v_lshl_add_u32 v164, v158, 2, s90
    s_barrier
    ds_read_b128 v[80:83], v152 offset:0
    ds_read_b64_tr_b16 v[96:97], v156 offset:0
    ds_read_b64_tr_b16 v[98:99], v156 offset:1280
    ds_read_b64_tr_b16 v[100:101], v157 offset:32
    ds_read_b64_tr_b16 v[102:103], v157 offset:1312
    ds_read_b128 v[84:87], v154 offset:0
    ds_read_b64_tr_b16 v[104:105], v156 offset:64
    ds_read_b64_tr_b16 v[106:107], v156 offset:1344
    ds_read_b128 v[88:91], v152 offset:4096
    ds_read_b64_tr_b16 v[108:109], v157 offset:96
    ds_read_b64_tr_b16 v[110:111], v157 offset:1376
    ds_read_b128 v[92:95], v154 offset:4096
    ds_read_b64_tr_b16 v[112:113], v156 offset:128
    ds_read_b64_tr_b16 v[114:115], v156 offset:1408
    s_branch L_QC_MIDQ
L_QC_LOOPQ:
    s_barrier
    v_mfma_f32_16x16x32_bf16 v[0:3], v[132:135], v[116:119], v[0:3]
    ds_read_b128 v[80:83], v152 offset:0
    v_mfma_f32_16x16x32_bf16 v[4:7], v[136:139], v[116:119], v[4:7]
    ds_read_b64_tr_b16 v[96:97], v156 offset:0
    v_mfma_f32_16x16x32_bf16 v[8:11], v[140:143], v[116:119], v[8:11]
    ds_read_b64_tr_b16 v[98:99], v156 offset:1280
    v_mfma_f32_16x16x32_bf16 v[12:15], v[144:147], v[116:119], v[12:15]
    ds_read_b64_tr_b16 v[100:101], v157 offset:32
    v_mfma_f32_16x16x32_bf16 v[16:19], v[148:151], v[116:119], v[16:19]
    ds_read_b64_tr_b16 v[102:103], v157 offset:1312
    v_mfma_f32_16x16x32_bf16 v[20:23], v[132:135], v[120:123], v[20:23]
    ds_read_b128 v[84:87], v154 offset:0
    v_mfma_f32_16x16x32_bf16 v[24:27], v[136:139], v[120:123], v[24:27]
    ds_read_b64_tr_b16 v[104:105], v156 offset:64
    v_mfma_f32_16x16x32_bf16 v[28:31], v[140:143], v[120:123], v[28:31]
    ds_read_b64_tr_b16 v[106:107], v156 offset:1344
    v_mfma_f32_16x16x32_bf16 v[32:35], v[144:147], v[120:123], v[32:35]
    ds_read_b128 v[88:91], v152 offset:4096
    v_mfma_f32_16x16x32_bf16 v[36:39], v[148:151], v[120:123], v[36:39]
    ds_read_b64_tr_b16 v[108:109], v157 offset:96
    v_mfma_f32_16x16x32_bf16 v[40:43], v[132:135], v[124:127], v[40:43]
    ds_read_b64_tr_b16 v[110:111], v157 offset:1376
    v_mfma_f32_16x16x32_bf16 v[44:47], v[136:139], v[124:127], v[44:47]
    ds_read_b128 v[92:95], v154 offset:4096
    v_mfma_f32_16x16x32_bf16 v[48:51], v[140:143], v[124:127], v[48:51]
    ds_read_b64_tr_b16 v[112:113], v156 offset:128
    v_mfma_f32_16x16x32_bf16 v[52:55], v[144:147], v[124:127], v[52:55]
    ds_read_b64_tr_b16 v[114:115], v156 offset:1408
    v_mfma_f32_16x16x32_bf16 v[56:59], v[148:151], v[124:127], v[56:59]
    v_mfma_f32_16x16x32_bf16 v[60:63], v[132:135], v[128:131], v[60:63]
    v_mfma_f32_16x16x32_bf16 v[64:67], v[136:139], v[128:131], v[64:67]
    v_mfma_f32_16x16x32_bf16 v[68:71], v[140:143], v[128:131], v[68:71]
    v_mfma_f32_16x16x32_bf16 v[72:75], v[144:147], v[128:131], v[72:75]
    v_mfma_f32_16x16x32_bf16 v[76:79], v[148:151], v[128:131], v[76:79]
L_QC_MIDQ:
    s_and_b32 s83, s91, 3
    s_mov_b32 s90, 36864
    s_cmp_eq_u32 s83, 3
    s_cmov_b32 s90, 4294856704
    s_add_u32 s91, s91, 1
    s_waitcnt lgkmcnt(0)
    v_mfma_f32_16x16x32_bf16 v[0:3], v[96:99], v[80:83], v[0:3]
    ds_read_b128 v[116:119], v153 offset:0
    v_mfma_f32_16x16x32_bf16 v[4:7], v[100:103], v[80:83], v[4:7]
    ds_read_b64_tr_b16 v[132:133], v156 offset:10240
    v_mfma_f32_16x16x32_bf16 v[8:11], v[104:107], v[80:83], v[8:11]
    ds_read_b64_tr_b16 v[134:135], v156 offset:11520
    v_mfma_f32_16x16x32_bf16 v[12:15], v[108:111], v[80:83], v[12:15]
    ds_read_b64_tr_b16 v[136:137], v157 offset:10272
    v_mfma_f32_16x16x32_bf16 v[16:19], v[112:115], v[80:83], v[16:19]
    ds_read_b64_tr_b16 v[138:139], v157 offset:11552
    v_mfma_f32_16x16x32_bf16 v[20:23], v[96:99], v[84:87], v[20:23]
    ds_read_b128 v[120:123], v155 offset:0
    v_mfma_f32_16x16x32_bf16 v[24:27], v[100:103], v[84:87], v[24:27]
    ds_read_b64_tr_b16 v[140:141], v156 offset:10304
    v_mfma_f32_16x16x32_bf16 v[28:31], v[104:107], v[84:87], v[28:31]
    ds_read_b64_tr_b16 v[142:143], v156 offset:11584
    v_mfma_f32_16x16x32_bf16 v[32:35], v[108:111], v[84:87], v[32:35]
    ds_read_b128 v[124:127], v153 offset:4096
    v_mfma_f32_16x16x32_bf16 v[36:39], v[112:115], v[84:87], v[36:39]
    ds_read_b64_tr_b16 v[144:145], v157 offset:10336
    v_mfma_f32_16x16x32_bf16 v[40:43], v[96:99], v[88:91], v[40:43]
    ds_read_b64_tr_b16 v[146:147], v157 offset:11616
    v_mfma_f32_16x16x32_bf16 v[44:47], v[100:103], v[88:91], v[44:47]
    ds_read_b128 v[128:131], v155 offset:4096
    v_mfma_f32_16x16x32_bf16 v[48:51], v[104:107], v[88:91], v[48:51]
    ds_read_b64_tr_b16 v[148:149], v156 offset:10368
    v_mfma_f32_16x16x32_bf16 v[52:55], v[108:111], v[88:91], v[52:55]
    ds_read_b64_tr_b16 v[150:151], v156 offset:11648
    v_mfma_f32_16x16x32_bf16 v[56:59], v[112:115], v[88:91], v[56:59]
    v_add_u32 v152, s90, v152
    v_mfma_f32_16x16x32_bf16 v[60:63], v[96:99], v[92:95], v[60:63]
    v_add_u32 v154, s90, v154
    v_mfma_f32_16x16x32_bf16 v[64:67], v[100:103], v[92:95], v[64:67]
    v_add_u32 v153, s90, v153
    v_mfma_f32_16x16x32_bf16 v[68:71], v[104:107], v[92:95], v[68:71]
    v_add_u32 v155, s90, v155
    v_mfma_f32_16x16x32_bf16 v[72:75], v[108:111], v[92:95], v[72:75]
    v_add_u32 v157, s90, v157
    v_mfma_f32_16x16x32_bf16 v[76:79], v[112:115], v[92:95], v[76:79]
    v_add_u32 v156, s90, v156
    s_cmp_lt_u32 s91, 10
    s_waitcnt lgkmcnt(0)
    s_cbranch_scc1 L_QC_LOOPQ
    ds_read_b64 v[168:169], v162 offset:0
    v_mfma_f32_16x16x32_bf16 v[0:3], v[132:135], v[116:119], v[0:3]
    ds_read_b64 v[170:171], v162 offset:128
    ds_read_b64 v[172:173], v162 offset:256
    ds_read_b64 v[174:175], v162 offset:384
    v_mfma_f32_16x16x32_bf16 v[20:23], v[132:135], v[120:123], v[20:23]
    ds_read_b64 v[176:177], v163 offset:0
    ds_read_b64 v[178:179], v163 offset:128
    ds_read_b64 v[180:181], v163 offset:256
    ds_read_b64 v[182:183], v163 offset:384
    v_mfma_f32_16x16x32_bf16 v[40:43], v[132:135], v[124:127], v[40:43]
    ds_read_b64 v[184:185], v163 offset:512
    ds_read_b32 v188, v164 offset:0
    ds_read_b32 v189, v164 offset:64
    v_mfma_f32_16x16x32_bf16 v[60:63], v[132:135], v[128:131], v[60:63]
    ds_read_b32 v190, v164 offset:128
    ds_read_b32 v191, v164 offset:192
    v_cmp_eq_u32 vcc, 0, v159
    v_mfma_f32_16x16x32_bf16 v[4:7], v[136:139], v[116:119], v[4:7]
    v_mfma_f32_16x16x32_bf16 v[24:27], v[136:139], v[120:123], v[24:27]
    v_mfma_f32_16x16x32_bf16 v[44:47], v[136:139], v[124:127], v[44:47]
    v_mfma_f32_16x16x32_bf16 v[64:67], v[136:139], v[128:131], v[64:67]
    s_waitcnt lgkmcnt(0)
    v_mfma_f32_16x16x32_bf16 v[8:11], v[140:143], v[116:119], v[8:11]
    v_cndmask_b32 v168, 0, v168, vcc
    v_cndmask_b32 v169, 0, v169, vcc
    v_cndmask_b32 v170, 0, v170, vcc
    v_cndmask_b32 v171, 0, v171, vcc
    v_mfma_f32_16x16x32_bf16 v[28:31], v[140:143], v[120:123], v[28:31]
    v_cndmask_b32 v172, 0, v172, vcc
    v_cndmask_b32 v173, 0, v173, vcc
    v_cndmask_b32 v174, 0, v174, vcc
    v_cndmask_b32 v175, 0, v175, vcc
    v_mfma_f32_16x16x16_bf16 v[0:3], v[176:177], v[168:169], v[0:3]
    v_mfma_f32_16x16x16_bf16 v[20:23], v[176:177], v[170:171], v[20:23]
    v_mfma_f32_16x16x16_bf16 v[40:43], v[176:177], v[172:173], v[40:43]
    v_mfma_f32_16x16x16_bf16 v[60:63], v[176:177], v[174:175], v[60:63]
    v_mfma_f32_16x16x16_bf16 v[4:7], v[178:179], v[168:169], v[4:7]
    s_nop 3
    v_mul_f32 v0, v188, v0
    v_mul_f32 v1, v188, v1
    v_mul_f32 v2, v188, v2
    v_mfma_f32_16x16x16_bf16 v[24:27], v[178:179], v[170:171], v[24:27]
    v_mul_f32 v3, v188, v3
    v_mul_f32 v20, v189, v20
    v_mul_f32 v21, v189, v21
    v_mfma_f32_16x16x32_bf16 v[48:51], v[140:143], v[124:127], v[48:51]
    v_mul_f32 v22, v189, v22
    v_mul_f32 v23, v189, v23
    v_cvt_pk_bf16_f32 v80, v0, v1
    v_mfma_f32_16x16x32_bf16 v[68:71], v[140:143], v[128:131], v[68:71]
    v_cvt_pk_bf16_f32 v81, v2, v3
    v_cvt_pk_bf16_f32 v82, v20, v21
    v_cvt_pk_bf16_f32 v83, v22, v23
    buffer_store_dwordx4 v[80:83], v160, s[20:23], s92 offen offset:0 sc1
    v_mfma_f32_16x16x16_bf16 v[44:47], v[178:179], v[172:173], v[44:47]
    v_mul_f32 v40, v190, v40
    v_mul_f32 v41, v190, v41
    v_mul_f32 v42, v190, v42
    v_mfma_f32_16x16x16_bf16 v[64:67], v[178:179], v[174:175], v[64:67]
    v_mul_f32 v43, v190, v43
    v_mul_f32 v60, v191, v60
    v_mul_f32 v61, v191, v61
    v_mfma_f32_16x16x32_bf16 v[12:15], v[144:147], v[116:119], v[12:15]
    v_mul_f32 v62, v191, v62
    v_mul_f32 v63, v191, v63
    v_cvt_pk_bf16_f32 v84, v40, v41
    v_mfma_f32_16x16x32_bf16 v[32:35], v[144:147], v[120:123], v[32:35]
    v_cvt_pk_bf16_f32 v85, v42, v43
    v_cvt_pk_bf16_f32 v86, v60, v61
    v_cvt_pk_bf16_f32 v87, v62, v63
    buffer_store_dwordx4 v[84:87], v160, s[20:23], s92 offen offset:256 sc1
    s_add_u32 s92, s92, 65536
    v_mfma_f32_16x16x16_bf16 v[8:11], v[180:181], v[168:169], v[8:11]
    v_mul_f32 v4, v188, v4
    v_mul_f32 v5, v188, v5
    v_mul_f32 v6, v188, v6
    v_mfma_f32_16x16x16_bf16 v[28:31], v[180:181], v[170:171], v[28:31]
    v_mul_f32 v7, v188, v7
    v_mul_f32 v24, v189, v24
    v_mul_f32 v25, v189, v25
    v_mfma_f32_16x16x32_bf16 v[52:55], v[144:147], v[124:127], v[52:55]
    v_mul_f32 v26, v189, v26
    v_mul_f32 v27, v189, v27
    v_cvt_pk_bf16_f32 v88, v4, v5
    v_mfma_f32_16x16x32_bf16 v[72:75], v[144:147], v[128:131], v[72:75]
    v_cvt_pk_bf16_f32 v89, v6, v7
    v_cvt_pk_bf16_f32 v90, v24, v25
    v_cvt_pk_bf16_f32 v91, v26, v27
    buffer_store_dwordx4 v[88:91], v160, s[20:23], s92 offen offset:0 sc1
    v_mfma_f32_16x16x16_bf16 v[48:51], v[180:181], v[172:173], v[48:51]
    v_mul_f32 v44, v190, v44
    v_mul_f32 v45, v190, v45
    v_mul_f32 v46, v190, v46
    v_mfma_f32_16x16x16_bf16 v[68:71], v[180:181], v[174:175], v[68:71]
    v_mul_f32 v47, v190, v47
    v_mul_f32 v64, v191, v64
    v_mul_f32 v65, v191, v65
    v_mfma_f32_16x16x32_bf16 v[16:19], v[148:151], v[116:119], v[16:19]
    v_mul_f32 v66, v191, v66
    v_mul_f32 v67, v191, v67
    v_cvt_pk_bf16_f32 v92, v44, v45
    v_mfma_f32_16x16x32_bf16 v[36:39], v[148:151], v[120:123], v[36:39]
    v_cvt_pk_bf16_f32 v93, v46, v47
    v_cvt_pk_bf16_f32 v94, v64, v65
    v_cvt_pk_bf16_f32 v95, v66, v67
    buffer_store_dwordx4 v[92:95], v160, s[20:23], s92 offen offset:256 sc1
    s_add_u32 s92, s92, 65536
    v_mfma_f32_16x16x16_bf16 v[12:15], v[182:183], v[168:169], v[12:15]
    v_mul_f32 v8, v188, v8
    v_mul_f32 v9, v188, v9
    v_mul_f32 v10, v188, v10
    v_mfma_f32_16x16x16_bf16 v[32:35], v[182:183], v[170:171], v[32:35]
    v_mul_f32 v11, v188, v11
    v_mul_f32 v28, v189, v28
    v_mul_f32 v29, v189, v29
    v_mfma_f32_16x16x32_bf16 v[56:59], v[148:151], v[124:127], v[56:59]
    v_mul_f32 v30, v189, v30
    v_mul_f32 v31, v189, v31
    v_cvt_pk_bf16_f32 v96, v8, v9
    v_mfma_f32_16x16x32_bf16 v[76:79], v[148:151], v[128:131], v[76:79]
    v_cvt_pk_bf16_f32 v97, v10, v11
    v_cvt_pk_bf16_f32 v98, v28, v29
    v_cvt_pk_bf16_f32 v99, v30, v31
    buffer_store_dwordx4 v[96:99], v160, s[20:23], s92 offen offset:0 sc1
    v_mfma_f32_16x16x16_bf16 v[52:55], v[182:183], v[172:173], v[52:55]
    v_mul_f32 v48, v190, v48
    v_mul_f32 v49, v190, v49
    v_mul_f32 v50, v190, v50
    v_mul_f32 v51, v190, v51
    v_mul_f32 v68, v191, v68
    v_mul_f32 v69, v191, v69
    v_mfma_f32_16x16x16_bf16 v[72:75], v[182:183], v[174:175], v[72:75]
    v_mul_f32 v70, v191, v70
    v_mul_f32 v71, v191, v71
    v_cvt_pk_bf16_f32 v100, v48, v49
    v_cvt_pk_bf16_f32 v101, v50, v51
    v_cvt_pk_bf16_f32 v102, v68, v69
    v_cvt_pk_bf16_f32 v103, v70, v71
    buffer_store_dwordx4 v[100:103], v160, s[20:23], s92 offen offset:256 sc1
    s_add_u32 s92, s92, 65536
    v_mfma_f32_16x16x16_bf16 v[16:19], v[184:185], v[168:169], v[16:19]
    v_mul_f32 v12, v188, v12
    v_mul_f32 v13, v188, v13
    v_mul_f32 v14, v188, v14
    v_mul_f32 v15, v188, v15
    v_mul_f32 v32, v189, v32
    v_mul_f32 v33, v189, v33
    v_mfma_f32_16x16x16_bf16 v[36:39], v[184:185], v[170:171], v[36:39]
    v_mul_f32 v34, v189, v34
    v_mul_f32 v35, v189, v35
    v_cvt_pk_bf16_f32 v104, v12, v13
    v_cvt_pk_bf16_f32 v105, v14, v15
    v_cvt_pk_bf16_f32 v106, v32, v33
    v_cvt_pk_bf16_f32 v107, v34, v35
    buffer_store_dwordx4 v[104:107], v160, s[20:23], s92 offen offset:0 sc1
    v_mfma_f32_16x16x16_bf16 v[56:59], v[184:185], v[172:173], v[56:59]
    v_mul_f32 v52, v190, v52
    v_mul_f32 v53, v190, v53
    v_mul_f32 v54, v190, v54
    v_mul_f32 v55, v190, v55
    v_mul_f32 v72, v191, v72
    v_mul_f32 v73, v191, v73
    v_mfma_f32_16x16x16_bf16 v[76:79], v[184:185], v[174:175], v[76:79]
    v_mul_f32 v74, v191, v74
    v_mul_f32 v75, v191, v75
    v_cvt_pk_bf16_f32 v108, v52, v53
    v_cvt_pk_bf16_f32 v109, v54, v55
    v_cvt_pk_bf16_f32 v110, v72, v73
    v_cvt_pk_bf16_f32 v111, v74, v75
    buffer_store_dwordx4 v[108:111], v160, s[20:23], s92 offen offset:256 sc1
    s_add_u32 s92, s92, 65536
    v_mul_f32 v16, v188, v16
    v_mul_f32 v17, v188, v17
    v_mul_f32 v18, v188, v18
    v_mul_f32 v19, v188, v19
    v_mul_f32 v36, v189, v36
    v_mul_f32 v37, v189, v37
    v_mul_f32 v38, v189, v38
    v_mul_f32 v39, v189, v39
    v_cvt_pk_bf16_f32 v112, v16, v17
    v_cvt_pk_bf16_f32 v113, v18, v19
    v_cvt_pk_bf16_f32 v114, v36, v37
    v_cvt_pk_bf16_f32 v115, v38, v39
    buffer_store_dwordx4 v[112:115], v160, s[20:23], s92 offen offset:0 sc1
    v_mul_f32 v56, v190, v56
    v_mul_f32 v57, v190, v57
    v_mul_f32 v58, v190, v58
    v_mul_f32 v59, v190, v59
    v_mul_f32 v76, v191, v76
    v_mul_f32 v77, v191, v77
    v_mul_f32 v78, v191, v78
    v_mul_f32 v79, v191, v79
    v_cvt_pk_bf16_f32 v204, v56, v57
    v_cvt_pk_bf16_f32 v205, v58, v59
    v_cvt_pk_bf16_f32 v206, v76, v77
    v_cvt_pk_bf16_f32 v207, v78, v79
    buffer_store_dwordx4 v[204:207], v160, s[20:23], s92 offen offset:256 sc1
    s_add_u32 s92, s92, 65536
    s_branch L_QC_FIN
L_QC_V:
    v_mul_u32_u24 v160, 10240, v159
    v_lshl_add_u32 v160, v158, 4, v160
    s_lshl_b32 s92, s36, 1
    s_add_u32 s92, s92, s88
    s_mul_i32 s92, s92, 81920
    s_sub_u32 s90, s37, 8
    s_lshl_b32 s90, s90, 1
    s_add_u32 s90, s90, s89
    s_mul_i32 s90, s90, 1280
    s_add_u32 s92, s92, s90
    s_add_u32 s92, s92, s7
    s_add_u32 s92, s92, 5308416
    s_add_u32 s93, s92, 40960
    s_lshl_b32 s90, s88, 9
    s_add_u32 s90, s90, 147456
    v_lshl_add_u32 v162, v158, 3, s90
    s_mul_i32 s83, s89, 640
    s_add_u32 s83, s83, 148992
    v_lshl_add_u32 v163, v158, 3, s83
    s_lshl_b32 s90, s88, 8
    s_add_u32 s90, s90, 148480
    v_lshl_add_u32 v164, v159, 4, s90
    s_barrier
    ds_read_b128 v[80:83], v152 offset:0
    ds_read_b64_tr_b16 v[96:97], v156 offset:0
    ds_read_b64_tr_b16 v[98:99], v156 offset:1280
    ds_read_b64_tr_b16 v[100:101], v157 offset:32
    ds_read_b64_tr_b16 v[102:103], v157 offset:1312
    ds_read_b128 v[84:87], v154 offset:0
    ds_read_b64_tr_b16 v[104:105], v156 offset:64
    ds_read_b64_tr_b16 v[106:107], v156 offset:1344
    ds_read_b128 v[88:91], v152 offset:4096
    ds_read_b64_tr_b16 v[108:109], v157 offset:96
    ds_read_b64_tr_b16 v[110:111], v157 offset:1376
    ds_read_b128 v[92:95], v154 offset:4096
    ds_read_b64_tr_b16 v[112:113], v156 offset:128
    ds_read_b64_tr_b16 v[114:115], v156 offset:1408
    s_branch L_QC_MIDV
L_QC_LOOPV:
    s_barrier
    v_mfma_f32_16x16x32_bf16 v[0:3], v[116:119], v[132:135], v[0:3]
    ds_read_b128 v[80:83], v152 offset:0
    v_mfma_f32_16x16x32_bf16 v[4:7], v[116:119], v[136:139], v[4:7]
    ds_read_b64_tr_b16 v[96:97], v156 offset:0
    v_mfma_f32_16x16x32_bf16 v[8:11], v[116:119], v[140:143], v[8:11]
    ds_read_b64_tr_b16 v[98:99], v156 offset:1280
    v_mfma_f32_16x16x32_bf16 v[12:15], v[116:119], v[144:147], v[12:15]
    ds_read_b64_tr_b16 v[100:101], v157 offset:32
    v_mfma_f32_16x16x32_bf16 v[16:19], v[116:119], v[148:151], v[16:19]
    ds_read_b64_tr_b16 v[102:103], v157 offset:1312
    v_mfma_f32_16x16x32_bf16 v[20:23], v[120:123], v[132:135], v[20:23]
    ds_read_b128 v[84:87], v154 offset:0
    v_mfma_f32_16x16x32_bf16 v[24:27], v[120:123], v[136:139], v[24:27]
    ds_read_b64_tr_b16 v[104:105], v156 offset:64
    v_mfma_f32_16x16x32_bf16 v[28:31], v[120:123], v[140:143], v[28:31]
    ds_read_b64_tr_b16 v[106:107], v156 offset:1344
    v_mfma_f32_16x16x32_bf16 v[32:35], v[120:123], v[144:147], v[32:35]
    ds_read_b128 v[88:91], v152 offset:4096
    v_mfma_f32_16x16x32_bf16 v[36:39], v[120:123], v[148:151], v[36:39]
    ds_read_b64_tr_b16 v[108:109], v157 offset:96
    v_mfma_f32_16x16x32_bf16 v[40:43], v[124:127], v[132:135], v[40:43]
    ds_read_b64_tr_b16 v[110:111], v157 offset:1376
    v_mfma_f32_16x16x32_bf16 v[44:47], v[124:127], v[136:139], v[44:47]
    ds_read_b128 v[92:95], v154 offset:4096
    v_mfma_f32_16x16x32_bf16 v[48:51], v[124:127], v[140:143], v[48:51]
    ds_read_b64_tr_b16 v[112:113], v156 offset:128
    v_mfma_f32_16x16x32_bf16 v[52:55], v[124:127], v[144:147], v[52:55]
    ds_read_b64_tr_b16 v[114:115], v156 offset:1408
    v_mfma_f32_16x16x32_bf16 v[56:59], v[124:127], v[148:151], v[56:59]
    v_mfma_f32_16x16x32_bf16 v[60:63], v[128:131], v[132:135], v[60:63]
    v_mfma_f32_16x16x32_bf16 v[64:67], v[128:131], v[136:139], v[64:67]
    v_mfma_f32_16x16x32_bf16 v[68:71], v[128:131], v[140:143], v[68:71]
    v_mfma_f32_16x16x32_bf16 v[72:75], v[128:131], v[144:147], v[72:75]
    v_mfma_f32_16x16x32_bf16 v[76:79], v[128:131], v[148:151], v[76:79]
L_QC_MIDV:
    s_and_b32 s83, s91, 3
    s_mov_b32 s90, 36864
    s_cmp_eq_u32 s83, 3
    s_cmov_b32 s90, 4294856704
    s_add_u32 s91, s91, 1
    s_waitcnt lgkmcnt(0)
    v_mfma_f32_16x16x32_bf16 v[0:3], v[80:83], v[96:99], v[0:3]
    ds_read_b128 v[116:119], v153 offset:0
    v_mfma_f32_16x16x32_bf16 v[4:7], v[80:83], v[100:103], v[4:7]
    ds_read_b64_tr_b16 v[132:133], v156 offset:10240
    v_mfma_f32_16x16x32_bf16 v[8:11], v[80:83], v[104:107], v[8:11]
    ds_read_b64_tr_b16 v[134:135], v156 offset:11520
    v_mfma_f32_16x16x32_bf16 v[12:15], v[80:83], v[108:111], v[12:15]
    ds_read_b64_tr_b16 v[136:137], v157 offset:10272
    v_mfma_f32_16x16x32_bf16 v[16:19], v[80:83], v[112:115], v[16:19]
    ds_read_b64_tr_b16 v[138:139], v157 offset:11552
    v_mfma_f32_16x16x32_bf16 v[20:23], v[84:87], v[96:99], v[20:23]
    ds_read_b128 v[120:123], v155 offset:0
    v_mfma_f32_16x16x32_bf16 v[24:27], v[84:87], v[100:103], v[24:27]
    ds_read_b64_tr_b16 v[140:141], v156 offset:10304
    v_mfma_f32_16x16x32_bf16 v[28:31], v[84:87], v[104:107], v[28:31]
    ds_read_b64_tr_b16 v[142:143], v156 offset:11584
    v_mfma_f32_16x16x32_bf16 v[32:35], v[84:87], v[108:111], v[32:35]
    ds_read_b128 v[124:127], v153 offset:4096
    v_mfma_f32_16x16x32_bf16 v[36:39], v[84:87], v[112:115], v[36:39]
    ds_read_b64_tr_b16 v[144:145], v157 offset:10336
    v_mfma_f32_16x16x32_bf16 v[40:43], v[88:91], v[96:99], v[40:43]
    ds_read_b64_tr_b16 v[146:147], v157 offset:11616
    v_mfma_f32_16x16x32_bf16 v[44:47], v[88:91], v[100:103], v[44:47]
    ds_read_b128 v[128:131], v155 offset:4096
    v_mfma_f32_16x16x32_bf16 v[48:51], v[88:91], v[104:107], v[48:51]
    ds_read_b64_tr_b16 v[148:149], v156 offset:10368
    v_mfma_f32_16x16x32_bf16 v[52:55], v[88:91], v[108:111], v[52:55]
    ds_read_b64_tr_b16 v[150:151], v156 offset:11648
    v_mfma_f32_16x16x32_bf16 v[56:59], v[88:91], v[112:115], v[56:59]
    v_add_u32 v152, s90, v152
    v_mfma_f32_16x16x32_bf16 v[60:63], v[92:95], v[96:99], v[60:63]
    v_add_u32 v154, s90, v154
    v_mfma_f32_16x16x32_bf16 v[64:67], v[92:95], v[100:103], v[64:67]
    v_add_u32 v153, s90, v153
    v_mfma_f32_16x16x32_bf16 v[68:71], v[92:95], v[104:107], v[68:71]
    v_add_u32 v155, s90, v155
    v_mfma_f32_16x16x32_bf16 v[72:75], v[92:95], v[108:111], v[72:75]
    v_add_u32 v157, s90, v157
    v_mfma_f32_16x16x32_bf16 v[76:79], v[92:95], v[112:115], v[76:79]
    v_add_u32 v156, s90, v156
    s_cmp_lt_u32 s91, 10
    s_waitcnt lgkmcnt(0)
    s_cbranch_scc1 L_QC_LOOPV
    ds_read_b64 v[168:169], v162 offset:0
    v_mfma_f32_16x16x32_bf16 v[0:3], v[116:119], v[132:135], v[0:3]
    ds_read_b64 v[170:171], v162 offset:128
    ds_read_b64 v[172:173], v162 offset:256
    ds_read_b64 v[174:175], v162 offset:384
    v_mfma_f32_16x16x32_bf16 v[20:23], v[120:123], v[132:135], v[20:23]
    ds_read_b64 v[176:177], v163 offset:0
    ds_read_b64 v[178:179], v163 offset:128
    ds_read_b64 v[180:181], v163 offset:256
    ds_read_b64 v[182:183], v163 offset:384
    v_mfma_f32_16x16x32_bf16 v[40:43], v[124:127], v[132:135], v[40:43]
    ds_read_b64 v[184:185], v163 offset:512
    ds_read_b128 v[188:191], v164 offset:0
    ds_read_b128 v[192:195], v164 offset:64
    v_mfma_f32_16x16x32_bf16 v[60:63], v[128:131], v[132:135], v[60:63]
    ds_read_b128 v[196:199], v164 offset:128
    ds_read_b128 v[200:203], v164 offset:192
    v_cmp_eq_u32 vcc, 0, v159
    v_mfma_f32_16x16x32_bf16 v[4:7], v[116:119], v[136:139], v[4:7]
    v_mfma_f32_16x16x32_bf16 v[24:27], v[120:123], v[136:139], v[24:27]
    v_mfma_f32_16x16x32_bf16 v[44:47], v[124:127], v[136:139], v[44:47]
    v_mfma_f32_16x16x32_bf16 v[64:67], v[128:131], v[136:139], v[64:67]
    s_waitcnt lgkmcnt(0)
    v_mfma_f32_16x16x32_bf16 v[8:11], v[116:119], v[140:143], v[8:11]
    v_cndmask_b32 v168, 0, v168, vcc
    v_cndmask_b32 v169, 0, v169, vcc
    v_cndmask_b32 v170, 0, v170, vcc
    v_cndmask_b32 v171, 0, v171, vcc
    v_mfma_f32_16x16x32_bf16 v[28:31], v[120:123], v[140:143], v[28:31]
    v_cndmask_b32 v172, 0, v172, vcc
    v_cndmask_b32 v173, 0, v173, vcc
    v_cndmask_b32 v174, 0, v174, vcc
    v_cndmask_b32 v175, 0, v175, vcc
    v_mfma_f32_16x16x16_bf16 v[0:3], v[168:169], v[176:177], v[0:3]
    v_mfma_f32_16x16x16_bf16 v[20:23], v[170:171], v[176:177], v[20:23]
    v_mfma_f32_16x16x16_bf16 v[40:43], v[172:173], v[176:177], v[40:43]
    v_mfma_f32_16x16x16_bf16 v[60:63], v[174:175], v[176:177], v[60:63]
    v_mfma_f32_16x16x16_bf16 v[4:7], v[168:169], v[178:179], v[4:7]
    s_nop 3
    v_mul_f32 v0, v188, v0
    v_mul_f32 v1, v189, v1
    v_mul_f32 v2, v190, v2
    v_mfma_f32_16x16x16_bf16 v[24:27], v[170:171], v[178:179], v[24:27]
    v_mul_f32 v3, v191, v3
    v_mul_f32 v20, v192, v20
    v_mul_f32 v21, v193, v21
    v_mfma_f32_16x16x32_bf16 v[48:51], v[124:127], v[140:143], v[48:51]
    v_mul_f32 v22, v194, v22
    v_mul_f32 v23, v195, v23
    v_cvt_pk_bf16_f32 v80, v0, v1
    v_mfma_f32_16x16x32_bf16 v[68:71], v[128:131], v[140:143], v[68:71]
    v_cvt_pk_bf16_f32 v81, v2, v3
    v_cvt_pk_bf16_f32 v82, v20, v21
    v_cvt_pk_bf16_f32 v83, v22, v23
    buffer_store_dwordx4 v[80:83], v160, s[20:23], s92 offen offset:0 sc1
    v_mfma_f32_16x16x16_bf16 v[44:47], v[172:173], v[178:179], v[44:47]
    v_mul_f32 v40, v196, v40
    v_mul_f32 v41, v197, v41
    v_mul_f32 v42, v198, v42
    v_mfma_f32_16x16x16_bf16 v[64:67], v[174:175], v[178:179], v[64:67]
    v_mul_f32 v43, v199, v43
    v_mul_f32 v60, v200, v60
    v_mul_f32 v61, v201, v61
    v_mfma_f32_16x16x32_bf16 v[12:15], v[116:119], v[144:147], v[12:15]
    v_mul_f32 v62, v202, v62
    v_mul_f32 v63, v203, v63
    v_cvt_pk_bf16_f32 v84, v40, v41
    v_mfma_f32_16x16x32_bf16 v[32:35], v[120:123], v[144:147], v[32:35]
    v_cvt_pk_bf16_f32 v85, v42, v43
    v_cvt_pk_bf16_f32 v86, v60, v61
    v_cvt_pk_bf16_f32 v87, v62, v63
    buffer_store_dwordx4 v[84:87], v160, s[20:23], s93 offen offset:0 sc1
    v_mfma_f32_16x16x16_bf16 v[8:11], v[168:169], v[180:181], v[8:11]
    v_mul_f32 v4, v188, v4
    v_mul_f32 v5, v189, v5
    v_mul_f32 v6, v190, v6
    v_mfma_f32_16x16x16_bf16 v[28:31], v[170:171], v[180:181], v[28:31]
    v_mul_f32 v7, v191, v7
    v_mul_f32 v24, v192, v24
    v_mul_f32 v25, v193, v25
    v_mfma_f32_16x16x32_bf16 v[52:55], v[124:127], v[144:147], v[52:55]
    v_mul_f32 v26, v194, v26
    v_mul_f32 v27, v195, v27
    v_cvt_pk_bf16_f32 v88, v4, v5
    v_mfma_f32_16x16x32_bf16 v[72:75], v[128:131], v[144:147], v[72:75]
    v_cvt_pk_bf16_f32 v89, v6, v7
    v_cvt_pk_bf16_f32 v90, v24, v25
    v_cvt_pk_bf16_f32 v91, v26, v27
    buffer_store_dwordx4 v[88:91], v160, s[20:23], s92 offen offset:256 sc1
    v_mfma_f32_16x16x16_bf16 v[48:51], v[172:173], v[180:181], v[48:51]
    v_mul_f32 v44, v196, v44
    v_mul_f32 v45, v197, v45
    v_mul_f32 v46, v198, v46
    v_mfma_f32_16x16x16_bf16 v[68:71], v[174:175], v[180:181], v[68:71]
    v_mul_f32 v47, v199, v47
    v_mul_f32 v64, v200, v64
    v_mul_f32 v65, v201, v65
    v_mfma_f32_16x16x32_bf16 v[16:19], v[116:119], v[148:151], v[16:19]
    v_mul_f32 v66, v202, v66
    v_mul_f32 v67, v203, v67
    v_cvt_pk_bf16_f32 v92, v44, v45
    v_mfma_f32_16x16x32_bf16 v[36:39], v[120:123], v[148:151], v[36:39]
    v_cvt_pk_bf16_f32 v93, v46, v47
    v_cvt_pk_bf16_f32 v94, v64, v65
    v_cvt_pk_bf16_f32 v95, v66, v67
    buffer_store_dwordx4 v[92:95], v160, s[20:23], s93 offen offset:256 sc1
    v_mfma_f32_16x16x16_bf16 v[12:15], v[168:169], v[182:183], v[12:15]
    v_mul_f32 v8, v188, v8
    v_mul_f32 v9, v189, v9
    v_mul_f32 v10, v190, v10
    v_mfma_f32_16x16x16_bf16 v[32:35], v[170:171], v[182:183], v[32:35]
    v_mul_f32 v11, v191, v11
    v_mul_f32 v28, v192, v28
    v_mul_f32 v29, v193, v29
    v_mfma_f32_16x16x32_bf16 v[56:59], v[124:127], v[148:151], v[56:59]
    v_mul_f32 v30, v194, v30
    v_mul_f32 v31, v195, v31
    v_cvt_pk_bf16_f32 v96, v8, v9
    v_mfma_f32_16x16x32_bf16 v[76:79], v[128:131], v[148:151], v[76:79]
    v_cvt_pk_bf16_f32 v97, v10, v11
    v_cvt_pk_bf16_f32 v98, v28, v29
    v_cvt_pk_bf16_f32 v99, v30, v31
    buffer_store_dwordx4 v[96:99], v160, s[20:23], s92 offen offset:512 sc1
    v_mfma_f32_16x16x16_bf16 v[52:55], v[172:173], v[182:183], v[52:55]
    v_mul_f32 v48, v196, v48
    v_mul_f32 v49, v197, v49
    v_mul_f32 v50, v198, v50
    v_mul_f32 v51, v199, v51
    v_mul_f32 v68, v200, v68
    v_mul_f32 v69, v201, v69
    v_mfma_f32_16x16x16_bf16 v[72:75], v[174:175], v[182:183], v[72:75]
    v_mul_f32 v70, v202, v70
    v_mul_f32 v71, v203, v71
    v_cvt_pk_bf16_f32 v100, v48, v49
    v_cvt_pk_bf16_f32 v101, v50, v51
    v_cvt_pk_bf16_f32 v102, v68, v69
    v_cvt_pk_bf16_f32 v103, v70, v71
    buffer_store_dwordx4 v[100:103], v160, s[20:23], s93 offen offset:512 sc1
    v_mfma_f32_16x16x16_bf16 v[16:19], v[168:169], v[184:185], v[16:19]
    v_mul_f32 v12, v188, v12
    v_mul_f32 v13, v189, v13
    v_mul_f32 v14, v190, v14
    v_mul_f32 v15, v191, v15
    v_mul_f32 v32, v192, v32
    v_mul_f32 v33, v193, v33
    v_mfma_f32_16x16x16_bf16 v[36:39], v[170:171], v[184:185], v[36:39]
    v_mul_f32 v34, v194, v34
    v_mul_f32 v35, v195, v35
    v_cvt_pk_bf16_f32 v104, v12, v13
    v_cvt_pk_bf16_f32 v105, v14, v15
    v_cvt_pk_bf16_f32 v106, v32, v33
    v_cvt_pk_bf16_f32 v107, v34, v35
    buffer_store_dwordx4 v[104:107], v160, s[20:23], s92 offen offset:768 sc1
    v_mfma_f32_16x16x16_bf16 v[56:59], v[172:173], v[184:185], v[56:59]
    v_mul_f32 v52, v196, v52
    v_mul_f32 v53, v197, v53
    v_mul_f32 v54, v198, v54
    v_mul_f32 v55, v199, v55
    v_mul_f32 v72, v200, v72
    v_mul_f32 v73, v201, v73
    v_mfma_f32_16x16x16_bf16 v[76:79], v[174:175], v[184:185], v[76:79]
    v_mul_f32 v74, v202, v74
    v_mul_f32 v75, v203, v75
    v_cvt_pk_bf16_f32 v108, v52, v53
    v_cvt_pk_bf16_f32 v109, v54, v55
    v_cvt_pk_bf16_f32 v110, v72, v73
    v_cvt_pk_bf16_f32 v111, v74, v75
    buffer_store_dwordx4 v[108:111], v160, s[20:23], s93 offen offset:768 sc1
    v_mul_f32 v16, v188, v16
    v_mul_f32 v17, v189, v17
    v_mul_f32 v18, v190, v18
    v_mul_f32 v19, v191, v19
    v_mul_f32 v36, v192, v36
    v_mul_f32 v37, v193, v37
    v_mul_f32 v38, v194, v38
    v_mul_f32 v39, v195, v39
    v_cvt_pk_bf16_f32 v112, v16, v17
    v_cvt_pk_bf16_f32 v113, v18, v19
    v_cvt_pk_bf16_f32 v114, v36, v37
    v_cvt_pk_bf16_f32 v115, v38, v39
    buffer_store_dwordx4 v[112:115], v160, s[20:23], s92 offen offset:1024 sc1
    v_mul_f32 v56, v196, v56
    v_mul_f32 v57, v197, v57
    v_mul_f32 v58, v198, v58
    v_mul_f32 v59, v199, v59
    v_mul_f32 v76, v200, v76
    v_mul_f32 v77, v201, v77
    v_mul_f32 v78, v202, v78
    v_mul_f32 v79, v203, v79
    v_cvt_pk_bf16_f32 v204, v56, v57
    v_cvt_pk_bf16_f32 v205, v58, v59
    v_cvt_pk_bf16_f32 v206, v76, v77
    v_cvt_pk_bf16_f32 v207, v78, v79
    buffer_store_dwordx4 v[204:207], v160, s[20:23], s93 offen offset:1024 sc1
L_QC_FIN:
    s_waitcnt vmcnt(0)
L_QC_FIN3:
    s_barrier
    s_cmp_lg_u32 s3, 0
    s_cbranch_scc1 L_WL_C
    s_mov_b64 s[56:57], s[42:43]
    s_mov_b32 s58, 1280
    s_mov_b32 s59, 0x20000
    s_and_b32 s83, s6, 3
    s_lshl_b32 s84, s38, 2
    s_add_u32 s83, s83, s84
    s_lshl_b32 s83, s83, 4
    v_and_b32 v160, 15, v253
    v_add_u32 v244, s83, v160
    s_mul_i32 s84, s39, 160
    s_lshr_b32 s85, s6, 2
    s_lshl_b32 s85, s85, 6
    s_add_u32 s85, s85, s84
    v_lshrrev_b32 v160, 4, v253
    v_lshlrev_b32 v160, 3, v160
    v_mul_u32_u24 v161, 1280, v244
    v_add_u32 v161, v161, v160
    buffer_load_dwordx2 v[238:239], v161, s[8:11], s85 offen
    buffer_load_dwordx2 v[240:241], v161, s[8:11], s85 offen offset:32
    buffer_load_dwordx2 v[242:243], v161, s[8:11], s84 offen offset:128
    buffer_load_dwordx2 v[232:233], v160, s[56:59], s85 offen
    buffer_load_dwordx2 v[234:235], v160, s[56:59], s85 offen offset:32
    buffer_load_dwordx2 v[236:237], v160, s[56:59], s84 offen offset:128
L_WL_C:
L_QKV_END:
    s_setprio 0
    s_lshl_b32 s36, s32, 2
    s_and_b32 s83, s33, 3
    s_add_u32 s36, s36, s83
    s_lshr_b32 s37, s33, 2
    v_lshlrev_b32 v59, 4, v244
    s_mov_b32 s90, 131072
    s_cmp_eq_u32 s3, 0
    s_cbranch_scc1 L_AT_R0
    buffer_load_dwordx4 v[60:63], v59, s[20:23], s90 offen sc1
L_AT_R0:
    v_and_b32 v148, 31, v253
    v_lshrrev_b32 v149, 5, v253
    s_lshl_b32 s83, s37, 4
    s_lshl_b32 s84, s6, 1
    s_add_u32 s83, s83, s84
    s_mul_i32 s83, s83, 20480
    s_add_u32 s83, s83, s7
    s_add_u32 s83, s83, 10551296
    s_lshl_b32 s4, s36, 9
    s_add_u32 s4, s4, s83
    s_lshl_b32 s84, s36, 7
    s_add_u32 s84, s84, s83
    s_add_u32 s5, s84, 16384
    v_lshrrev_b32 v152, 4, v148
    v_mul_u32_u24 v152, 20480, v152
    v_and_b32 v154, 15, v148
    v_lshl_add_u32 v153, v154, 4, v152
    v_lshl_add_u32 v57, v149, 8, v153
    v_lshl_add_u32 v58, v154, 3, v152
    v_mov_b32 v96, -1
    v_mov_b32 v97, -1
    v_mov_b32 v98, -1
    v_mov_b32 v99, -1
    buffer_store_dwordx4 v[96:99], v57, s[20:23], s4 offen sc1
    s_mov_b32 exec_hi, 0
    buffer_store_dwordx2 v[96:97], v58, s[20:23], s5 offen sc1
    s_mov_b64 exec, -1
    s_cmp_eq_u32 s3, 0
    s_cbranch_scc1 L_AT_Q0
    s_cmp_ge_u32 s41, 48
    s_cbranch_scc1 L_AT_Q0
    s_sub_u32 s83, s33, 24
    s_lshr_b32 s86, s83, 1
    s_lshl_b32 s86, s86, 4
    s_and_b32 s83, s83, 1
    s_add_u32 s86, s86, s83
    s_lshl_b32 s83, s32, 1
    s_add_u32 s86, s86, s83
    s_cmp_lt_u32 s6, 3
    s_cbranch_scc1 L_Q8_A
    v_add_u32 v92, 0, v253
    v_mul_u32_u24 v93, 205, v92
    v_lshrrev_b32 v93, 10, v93
    v_lshlrev_b32 v92, 4, v92
    v_mul_u32_u24 v93, 3760, v93
    v_add_u32 v68, v92, v93
    v_add_u32 v92, 64, v253
    v_mul_u32_u24 v93, 205, v92
    v_lshrrev_b32 v93, 10, v93
    v_lshlrev_b32 v92, 4, v92
    v_mul_u32_u24 v93, 3760, v93
    v_add_u32 v69, v92, v93
    v_add_u32 v92, 128, v253
    v_mul_u32_u24 v93, 205, v92
    v_lshrrev_b32 v93, 10, v93
    v_lshlrev_b32 v92, 4, v92
    v_mul_u32_u24 v93, 3760, v93
    v_add_u32 v70, v92, v93
    v_add_u32 v92, 192, v253
    v_mul_u32_u24 v93, 205, v92
    v_lshrrev_b32 v93, 10, v93
    v_lshlrev_b32 v92, 4, v92
    v_mul_u32_u24 v93, 3760, v93
    v_add_u32 v71, v92, v93
    v_add_u32 v92, 256, v253
    v_mul_u32_u24 v93, 205, v92
    v_lshrrev_b32 v93, 10, v93
    v_lshlrev_b32 v92, 4, v92
    v_mul_u32_u24 v93, 3760, v93
    v_add_u32 v72, v92, v93
    s_sub_u32 s83, s6, 3
    s_mul_i32 s84, s83, 10240
    s_add_u32 m0, s84, 57344
    s_mul_i32 s83, s83, 491520
    s_mul_i32 s84, s86, 80
    s_add_u32 s83, s83, s84
    buffer_load_dwordx4 v68, s[12:15], s83 offen lds
    s_add_u32 m0, m0, 1024
    s_nop 0
    buffer_load_dwordx4 v69, s[12:15], s83 offen lds
    s_add_u32 m0, m0, 1024
    s_nop 0
    buffer_load_dwordx4 v70, s[12:15], s83 offen lds
    s_add_u32 m0, m0, 1024
    s_nop 0
    buffer_load_dwordx4 v71, s[12:15], s83 offen lds
    s_add_u32 m0, m0, 1024
    s_nop 0
    buffer_load_dwordx4 v72, s[12:15], s83 offen lds
    s_add_u32 m0, m0, 1024
    s_add_u32 s83, s83, 245760
    buffer_load_dwordx4 v68, s[12:15], s83 offen lds
    s_add_u32 m0, m0, 1024
    s_nop 0
    buffer_load_dwordx4 v69, s[12:15], s83 offen lds
    s_add_u32 m0, m0, 1024
    s_nop 0
    buffer_load_dwordx4 v70, s[12:15], s83 offen lds
    s_add_u32 m0, m0, 1024
    s_nop 0
    buffer_load_dwordx4 v71, s[12:15], s83 offen lds
    s_add_u32 m0, m0, 1024
    s_nop 0
    buffer_load_dwordx4 v72, s[12:15], s83 offen lds
    s_add_u32 m0, m0, 1024
    s_branch L_Q8_B
L_Q8_A:
    v_min_u32 v92, 159, v254
    v_mul_u32_u24 v74, 205, v92
    v_lshrrev_b32 v74, 12, v74
    v_mul_u32_u24 v75, 20, v74
    v_sub_u32 v75, v92, v75
    v_lshlrev_b32 v75, 1, v75
    v_lshrrev_b32 v76, 2, v75
    v_lshlrev_b32 v76, 8, v76
    v_lshl_add_u32 v76, v74, 4, v76
    v_and_b32 v92, 2, v75
    v_lshl_add_u32 v76, v92, 2, v76
    s_mul_i32 s83, s86, 640
    s_add_u32 s83, s83, 1081344
    v_lshlrev_b32 v92, 4, v75
    v_add_u32 v76, 110592, v76
    buffer_load_dwordx4 v[80:83], v92, s[20:23], s83 offen sc1
    buffer_load_dwordx4 v[84:87], v92, s[20:23], s83 offen offset:16 sc1
L_Q8_B:
    s_sub_u32 s83, s33, 24
    s_lshr_b32 s86, s83, 1
    s_lshl_b32 s86, s86, 4
    s_and_b32 s83, s83, 1
    s_add_u32 s86, s86, s83
    s_lshl_b32 s83, s32, 1
    s_add_u32 s86, s86, s83
    s_mul_i32 s83, s6, 2560
    s_add_u32 s83, s83, 57344
    v_lshrrev_b32 v66, 4, v253
    v_and_b32 v67, 7, v253
    v_lshrrev_b32 v92, 4, v253
    v_bfe_u32 v94, v253, 2, 2
    v_lshl_add_u32 v94, v92, 3, v94
    v_mul_u32_u24 v94, 80, v94
    v_and_b32 v92, 3, v253
    v_lshl_add_u32 v94, v92, 3, v94
    v_add_u32 v94, s83, v94
    v_mov_b32 v0, s35
    v_mov_b32 v1, s35
    v_mov_b32 v2, s35
    v_mov_b32 v3, s35
    v_mov_b32 v4, s35
    v_mov_b32 v5, s35
    v_mov_b32 v6, s35
    v_mov_b32 v7, s35
    v_mov_b32 v8, s35
    v_mov_b32 v9, s35
    v_mov_b32 v10, s35
    v_mov_b32 v11, s35
    v_mul_u32_u24 v95, 80, v67
    s_add_u32 s83, s6, 0
    s_min_u32 s83, s83, 19
    s_lshl_b32 s83, s83, 2
    v_add_u32 v92, s83, v66
    v_mul_u32_u24 v93, 205, v92
    v_lshrrev_b32 v93, 10, v93
    v_mul_u32_u24 v93, 560, v93
    v_lshl_add_u32 v93, v92, 4, v93
    v_add_u32 v88, v93, v95
    s_add_u32 s83, s6, 8
    s_min_u32 s83, s83, 19
    s_lshl_b32 s83, s83, 2
    v_add_u32 v92, s83, v66
    v_mul_u32_u24 v93, 205, v92
    v_lshrrev_b32 v93, 10, v93
    v_mul_u32_u24 v93, 560, v93
    v_lshl_add_u32 v93, v92, 4, v93
    v_add_u32 v89, v93, v95
    s_add_u32 s83, s6, 16
    s_min_u32 s83, s83, 19
    s_lshl_b32 s83, s83, 2
    v_add_u32 v92, s83, v66
    v_mul_u32_u24 v93, 205, v92
    v_lshrrev_b32 v93, 10, v93
    v_mul_u32_u24 v93, 560, v93
    v_lshl_add_u32 v93, v92, 4, v93
    v_add_u32 v90, v93, v95
    s_mul_i32 s83, s32, 10240
    s_add_u32 s83, s83, 294912
    s_lshl_b32 s84, s6, 12
    s_add_u32 s84, s84, 110592
    v_lshlrev_b32 v97, 4, v253
    v_add_u32 v97, s84, v97
    v_lshlrev_b32 v92, 4, v74
    v_add_u32 v92, 110592, v92
    v_lshrrev_b32 v93, 2, v74
    v_lshl_add_u32 v93, v93, 8, v92
    v_and_b32 v95, 3, v74
    v_lshl_add_u32 v93, v95, 2, v93
    s_waitcnt vmcnt(0)
    s_barrier
    ds_read_b64_tr_b16 v[12:13], v94 offset:0
    ds_read_b64_tr_b16 v[14:15], v94 offset:320
    ds_read_b64_tr_b16 v[16:17], v94 offset:32
    ds_read_b64_tr_b16 v[18:19], v94 offset:352
    ds_read_b64_tr_b16 v[20:21], v94 offset:64
    ds_read_b64_tr_b16 v[22:23], v94 offset:384
    ds_read_b64_tr_b16 v[24:25], v94 offset:20480
    ds_read_b64_tr_b16 v[26:27], v94 offset:20800
    ds_read_b64_tr_b16 v[28:29], v94 offset:20512
    ds_read_b64_tr_b16 v[30:31], v94 offset:20832
    ds_read_b64_tr_b16 v[32:33], v94 offset:20544
    ds_read_b64_tr_b16 v[34:35], v94 offset:20864
    ds_read_b64_tr_b16 v[36:37], v94 offset:40960
    ds_read_b64_tr_b16 v[38:39], v94 offset:41280
    ds_read_b64_tr_b16 v[40:41], v94 offset:40992
    ds_read_b64_tr_b16 v[42:43], v94 offset:41312
    ds_read_b64_tr_b16 v[44:45], v94 offset:41024
    ds_read_b64_tr_b16 v[46:47], v94 offset:41344
    v_add_f32 v80, v80, v82
    v_add_f32 v81, v84, v86
    s_mov_b32 exec_lo, 0x00ff00ff
    s_mov_b32 exec_hi, 0x00ff00ff
    s_mov_b32 s82, 0
L_PFQ8:
    buffer_load_dwordx4 v[0:3], v88, s[20:23], s83 offen sc1
    buffer_load_dwordx4 v[4:7], v89, s[20:23], s83 offen sc1
    buffer_load_dwordx4 v[8:11], v90, s[20:23], s83 offen sc1
L_PWQ8:
    s_add_u32 s82, s82, 1
    s_waitcnt vmcnt(0)
    v_min3_u32 v96, v0, v1, v2
    v_min3_u32 v96, v96, v3, v4
    v_min3_u32 v96, v96, v5, v6
    v_min3_u32 v96, v96, v7, v8
    v_min3_u32 v96, v96, v9, v10
    v_min_u32 v96, v96, v11
    v_cmp_eq_u32 vcc, 0, v96
    s_nop 0
    s_cbranch_vccz L_PXQ8
    s_cmp_gt_u32 s82, 131072
    s_sleep 12
    s_cbranch_scc0 L_PFQ8
L_PXQ8:
    s_mov_b64 exec, -1
    s_waitcnt lgkmcnt(0)
    v_mfma_f32_16x16x32_bf16 v[108:111], v[12:15], v[0:3], 0
    v_mfma_f32_16x16x32_bf16 v[112:115], v[16:19], v[0:3], 0
    v_mfma_f32_16x16x32_bf16 v[116:119], v[20:23], v[0:3], 0
    v_mfma_f32_16x16x32_bf16 v[120:123], v[0:3], v[0:3], 0
    v_mfma_f32_16x16x32_bf16 v[108:111], v[24:27], v[4:7], v[108:111]
    v_mfma_f32_16x16x32_bf16 v[112:115], v[28:31], v[4:7], v[112:115]
    v_mfma_f32_16x16x32_bf16 v[116:119], v[32:35], v[4:7], v[116:119]
    v_mfma_f32_16x16x32_bf16 v[120:123], v[4:7], v[4:7], v[120:123]
    s_cmp_ge_u32 s6, 4
    s_cbranch_scc1 L_Q8_M
    v_mfma_f32_16x16x32_bf16 v[108:111], v[36:39], v[8:11], v[108:111]
    v_mfma_f32_16x16x32_bf16 v[112:115], v[40:43], v[8:11], v[112:115]
    v_mfma_f32_16x16x32_bf16 v[116:119], v[44:47], v[8:11], v[116:119]
    v_mfma_f32_16x16x32_bf16 v[120:123], v[8:11], v[8:11], v[120:123]
L_Q8_M:
    s_nop 4
    ds_write_b128 v97, v[108:111] offset:0
    ds_write_b128 v97, v[112:115] offset:1024
    ds_write_b128 v97, v[116:119] offset:2048
    ds_write_b128 v97, v[120:123] offset:3072
    s_waitcnt lgkmcnt(0)
    s_barrier
    s_cmp_ge_u32 s6, 3
    s_cbranch_scc1 L_Q8_END
    ds_read_b32 v12, v92 offset:3584
    ds_read_b32 v20, v93 offset:3072
    ds_read_b32 v13, v92 offset:7680
    ds_read_b32 v21, v93 offset:7168
    ds_read_b32 v14, v92 offset:11776
    ds_read_b32 v22, v93 offset:11264
    ds_read_b32 v15, v92 offset:15872
    ds_read_b32 v23, v93 offset:15360
    ds_read_b32 v16, v92 offset:19968
    ds_read_b32 v24, v93 offset:19456
    ds_read_b32 v17, v92 offset:24064
    ds_read_b32 v25, v93 offset:23552
    ds_read_b32 v18, v92 offset:28160
    ds_read_b32 v26, v93 offset:27648
    ds_read_b32 v19, v92 offset:32256
    ds_read_b32 v27, v93 offset:31744
    ds_read_b64 v[28:29], v76 offset:0
    ds_read_b64 v[30:31], v76 offset:4096
    ds_read_b64 v[32:33], v76 offset:8192
    ds_read_b64 v[34:35], v76 offset:12288
    ds_read_b64 v[36:37], v76 offset:16384
    ds_read_b64 v[38:39], v76 offset:20480
    ds_read_b64 v[40:41], v76 offset:24576
    ds_read_b64 v[42:43], v76 offset:28672
    v_min_u32 v94, 159, v254
    v_lshlrev_b32 v94, 2, v94
    s_mul_i32 s83, s86, 640
    s_add_u32 s83, s83, 262144
    s_cmp_lt_u32 s86, 16
    s_cselect_b32 s84, 0x3ea52b5c, 1.0
    s_waitcnt lgkmcnt(8)
    v_add_f32 v12, v12, v13
    v_add_f32 v20, v20, v21
    v_add_f32 v14, v14, v15
    v_add_f32 v22, v22, v23
    v_add_f32 v16, v16, v17
    v_add_f32 v24, v24, v25
    v_add_f32 v18, v18, v19
    v_add_f32 v26, v26, v27
    v_add_f32 v12, v12, v14
    v_add_f32 v20, v20, v22
    v_add_f32 v16, v16, v18
    v_add_f32 v24, v24, v26
    v_add_f32 v12, v12, v16
    v_add_f32 v20, v20, v24
    v_mul_f32 v95, 0x3acccccd, v12
    v_mul_f32 v96, 0x3acccccd, v20
    v_fma_f32 v96, -v95, v95, v96
    v_max_f32 v96, 0, v96
    v_cvt_pk_bf16_f32 v64, v95, v95
    v_and_b32 v64, 0xffff0000, v64
    v_cvt_pk_bf16_f32 v97, v96, v96
    v_and_b32 v97, 0xffff0000, v97
    v_add_f32 v97, 0x3727c5ac, v97
    v_cvt_pk_bf16_f32 v97, v97, v97
    v_and_b32 v97, 0xffff0000, v97
    v_sqrt_f32 v65, v97
    s_nop 0
    v_cvt_pk_bf16_f32 v65, v65, v65
    v_and_b32 v65, 0xffff0000, v65
    v_rcp_f32 v65, v65
    s_waitcnt lgkmcnt(0)
    v_add_f32 v28, v28, v30
    v_add_f32 v29, v29, v31
    v_add_f32 v32, v32, v34
    v_add_f32 v33, v33, v35
    v_add_f32 v36, v36, v38
    v_add_f32 v37, v37, v39
    v_add_f32 v40, v40, v42
    v_add_f32 v41, v41, v43
    v_add_f32 v28, v28, v32
    v_add_f32 v29, v29, v33
    v_add_f32 v36, v36, v40
    v_add_f32 v37, v37, v41
    v_add_f32 v28, v28, v36
    v_add_f32 v29, v29, v37
    v_mul_f32 v65, s84, v65
    v_fma_f32 v28, -v64, v80, v28
    v_fma_f32 v29, -v64, v81, v29
    v_mul_f32 v28, v65, v28
    v_mul_f32 v29, v65, v29
    v_cvt_pk_bf16_f32 v28, v28, v29
    v_max_u32 v28, 1, v28
    buffer_store_dword v28, v94, s[20:23], s83 offen sc1
L_Q8_END:
L_AT_Q0:
    v_lshlrev_b32 v156, 4, v253
    s_add_u32 s83, s7, 5308416
    s_add_u32 s28, s20, s83
    s_addc_u32 s29, s21, 0
    s_mov_b32 s30, 2621440
    s_and_b32 s83, s6, 1
    s_mul_i32 s83, s83, 33
    s_lshl_b32 s84, s37, 5
    s_add_u32 s84, s84, s83
    s_sub_u32 s84, s84, 32
    s_mul_i32 s84, s84, 10240
    s_mul_i32 s85, s36, 320
    s_add_u32 s84, s84, s85
    v_mul_u32_u24 v157, 49, v253
    v_lshrrev_b32 v157, 10, v157
    v_mul_u32_u24 v157, 9904, v157
    v_add3_u32 v157, v157, v156, s84
    s_mul_i32 s83, s83, 336
    s_add_u32 m0, s83, 34816
    s_cmp_lg_u32 s6, 0
    s_cbranch_scc0 L_AT_W0
    s_sub_u32 s86, s6, 1
    s_mul_i32 s83, s36, 5
    s_add_u32 s83, s83, s86
    s_lshl_b32 s83, s83, 14
    s_lshl_b32 s84, s37, 11
    s_add_u32 s83, s83, s84
    s_add_u32 s83, s83, s7
    s_add_u32 s83, s83, 65536
    s_add_u32 s84, s83, 2619392
    s_mov_b32 s85, s84
    s_cmp_eq_u32 s37, 0
    s_cmov_b32 s85, 0x7f000000
    s_branch L_AT_W
L_AT_W0:
    s_lshl_b32 s83, s36, 3
    s_add_u32 s83, s83, s37
    s_mul_i32 s83, s83, 512
    s_add_u32 s83, s83, s34
    s_add_u32 s83, s83, 0
    s_cmp_eq_u32 s37, 0
    s_cselect_b32 s84, 6, 12
    v_lshlrev_b32 v152, 7, v253
    s_mov_b32 exec_lo, 1
    s_mov_b32 exec_hi, 0
    s_mov_b32 s82, 0
POLL_5:
    buffer_load_dword v153, v152, s[20:23], s83 offen sc1
    s_add_u32 s82, s82, 1
    s_cmp_gt_u32 s82, 131072
    s_cbranch_scc1 POLLX_6
    s_waitcnt vmcnt(0)
    v_cmp_ne_u32 vcc, s84, v153
    s_nop 0
    s_cbranch_vccnz POLL_5
POLLX_6:
    s_waitcnt vmcnt(0)
    s_mov_b64 exec, -1
L_AT_W:
    s_cmp_eq_u32 s3, 0
    s_cbranch_scc1 L_AT_W2
    s_waitcnt vmcnt(2)
L_AT_W2:
    s_barrier
    s_cmp_eq_u32 s6, 0
    s_cbranch_scc1 L_AT_S
    s_cmp_ge_u32 s6, 6
    s_cbranch_scc1 L_AT_V
    s_lshl_b32 m0, s86, 12
    s_lshl_b32 s86, s86, 11
    buffer_load_dwordx4 v156, s[20:23], s84 offen offset:2048 sc1 lds
    buffer_load_dwordx4 v156, s[20:23], s84 offen offset:3072 sc1 lds
    buffer_load_dwordx4 v156, s[20:23], s85 offen offset:0 sc1 lds
    buffer_load_dwordx4 v156, s[20:23], s85 offen offset:1024 sc1 lds
    s_add_u32 m0, s86, 24576
    s_nop 0
    buffer_load_dwordx4 v156, s[20:23], s83 offen offset:0 sc1 lds
    buffer_load_dwordx4 v156, s[20:23], s83 offen offset:1024 sc1 lds
    s_branch L_AT_S
L_AT_V:
    s_mov_b32 exec_lo, 0xffefffff
    s_mov_b32 exec_hi, 0x3ffffdff
    buffer_load_dwordx4 v157, s[28:31], 0 offen sc1 lds
    s_add_u32 m0, m0, 1008
    v_add_u32 v157, 30720, v157
    buffer_load_dwordx4 v157, s[28:31], 0 offen sc1 lds
    s_add_u32 m0, m0, 1008
    v_add_u32 v157, 30720, v157
    buffer_load_dwordx4 v157, s[28:31], 0 offen sc1 lds
    s_add_u32 m0, m0, 1008
    v_add_u32 v157, 30720, v157
    buffer_load_dwordx4 v157, s[28:31], 0 offen sc1 lds
    s_add_u32 m0, m0, 1008
    v_add_u32 v157, 30720, v157
    buffer_load_dwordx4 v157, s[28:31], 0 offen sc1 lds
    s_add_u32 m0, m0, 1008
    v_add_u32 v157, 30720, v157
    buffer_load_dwordx4 v157, s[28:31], 0 offen sc1 lds
    s_add_u32 m0, m0, 1008
    v_add_u32 v157, 30720, v157
    buffer_load_dwordx4 v157, s[28:31], 0 offen sc1 lds
    s_add_u32 m0, m0, 1008
    v_add_u32 v157, 30720, v157
    buffer_load_dwordx4 v157, s[28:31], 0 offen sc1 lds
    s_add_u32 m0, m0, 1008
    v_add_u32 v157, 30720, v157
    buffer_load_dwordx4 v157, s[28:31], 0 offen sc1 lds
    s_add_u32 m0, m0, 1008
    v_add_u32 v157, 30720, v157
    buffer_load_dwordx4 v157, s[28:31], 0 offen sc1 lds
    s_add_u32 m0, m0, 1008
    v_add_u32 v157, 30720, v157
    buffer_load_dwordx4 v157, s[28:31], 0 offen sc1 lds
    s_mov_b64 exec, -1
L_AT_S:
    s_cmp_eq_u32 s6, 5
    s_cselect_b64 s[92:93], s[46:47], s[48:49]
    s_cmp_lt_u32 s6, 5
    s_cmov_b64 s[92:93], s[12:13]
    s_mov_b32 s94, 1966080
    s_cmov_b32 s94, 2457600
    s_mov_b32 s95, 0x20000
    v_min_u32 v152, 59, v253
    s_cbranch_scc0 L_TS_B
    s_mul_i32 s83, s33, 5
    s_add_u32 s83, s83, s6
    s_mul_i32 s83, s83, 15360
    s_lshr_b32 s84, s32, 1
    s_mul_i32 s84, s84, 320
    s_add_u32 s83, s83, s84
    v_min_u32 v152, 35, v253
    v_mul_u32_u24 v153, 86, v152
    v_lshrrev_b32 v153, 8, v153
    v_mul_u32_u24 v153, 896, v153
    s_branch L_TS_X
L_TS_B:
    s_mul_i32 s83, s33, 61440
    s_mul_i32 s84, s32, 384
    s_add_u32 s83, s83, s84
    v_mul_u32_u24 v153, 86, v152
    v_lshrrev_b32 v153, 8, v153
    v_mul_u32_u24 v153, 2688, v153
L_TS_X:
    v_lshl_add_u32 v152, v152, 7, v153
    v_add_u32 v158, s83, v152
    s_cmp_eq_u32 s37, 0
    s_cselect_b32 s83, 4, 0
    s_cmp_lt_u32 s6, s83
    s_cselect_b32 s83, 0xf149, 0
    v_mov_b32 v152, s83
    v_mov_b32 v153, 0
    v_lshlrev_b32 v154, 3, v254
    ds_write_b64 v154, v[152:153] offset:20480
    v_lshlrev_b32 v154, 3, v149
    v_sub_u32 v154, v148, v154
    v_cmp_le_i32 s[50:51], 0, v154
    v_cmp_le_i32 s[52:53], 1, v154
    v_cmp_le_i32 s[54:55], 2, v154
    v_cmp_le_i32 s[56:57], 3, v154
    v_cmp_le_i32 s[58:59], 4, v154
    v_cmp_le_i32 s[60:61], 5, v154
    v_cmp_le_i32 s[62:63], 6, v154
    v_cmp_le_i32 s[64:65], 7, v154
    v_cmp_le_i32 s[66:67], 16, v154
    v_cmp_le_i32 s[68:69], 17, v154
    v_cmp_le_i32 s[70:71], 18, v154
    v_cmp_le_i32 s[72:73], 19, v154
    v_cmp_le_i32 s[74:75], 20, v154
    v_cmp_le_i32 s[76:77], 21, v154
    v_cmp_le_i32 s[78:79], 22, v154
    v_cmp_le_i32 s[80:81], 23, v154
    v_mov_b32 v156, 0xffff
    v_mov_b32 v157, 0xffff0000
    v_cndmask_b32 v48, 0, v156, s[50:51]
    v_cndmask_b32 v155, 0, v157, s[52:53]
    v_or_b32 v48, v48, v155
    v_cndmask_b32 v49, 0, v156, s[54:55]
    v_cndmask_b32 v155, 0, v157, s[56:57]
    v_or_b32 v49, v49, v155
    v_cndmask_b32 v50, 0, v156, s[58:59]
    v_cndmask_b32 v155, 0, v157, s[60:61]
    v_or_b32 v50, v50, v155
    v_cndmask_b32 v51, 0, v156, s[62:63]
    v_cndmask_b32 v155, 0, v157, s[64:65]
    v_or_b32 v51, v51, v155
    v_cndmask_b32 v52, 0, v156, s[66:67]
    v_cndmask_b32 v155, 0, v157, s[68:69]
    v_or_b32 v52, v52, v155
    v_cndmask_b32 v53, 0, v156, s[70:71]
    v_cndmask_b32 v155, 0, v157, s[72:73]
    v_or_b32 v53, v53, v155
    v_cndmask_b32 v54, 0, v156, s[74:75]
    v_cndmask_b32 v155, 0, v157, s[76:77]
    v_or_b32 v54, v54, v155
    v_cndmask_b32 v55, 0, v156, s[78:79]
    v_cndmask_b32 v155, 0, v157, s[80:81]
    v_or_b32 v55, v55, v155
    v_and_b32 v155, 0x13, v148
    v_and_b32 v156, 4, v148
    v_lshl_or_b32 v155, v156, 1, v155
    v_and_b32 v156, 8, v148
    v_lshrrev_b32 v156, 1, v156
    v_or_b32 v155, v155, v156
    s_lshl_b32 s83, s6, 8
    v_lshlrev_b32 v156, 3, v155
    v_add_u32 v156, s83, v156
    v_lshl_add_u32 v144, v149, 13, v156
    v_lshl_add_u32 v145, v149, 12, v156
    v_add_u32 v145, 16384, v145
    v_lshlrev_b32 v147, 3, v148
    v_add_u32 v147, s83, v147
    v_add_u32 v147, 24576, v147
    v_min_u32 v156, 20, v155
    v_mul_u32_u24 v157, 336, v149
    v_lshl_add_u32 v156, v156, 4, v157
    s_mul_i32 s83, s6, 1344
    s_add_u32 s83, s83, 34816
    v_add_u32 v146, s83, v156
    v_mov_b32 v100, s35
    v_mov_b32 v101, s35
    v_mov_b32 v102, s35
    v_mov_b32 v103, s35
    v_mul_u32_u24 v104, 336, v253
    ds_write_b128 v104, v[100:103] offset:35136
    s_cmp_eq_u32 s3, 0
    s_cbranch_scc1 L_AT_R2
    s_mov_b32 s82, 0
L_AT_R1:
    v_cmp_gt_f32 vcc, 0x42000000, v63
    s_nop 0
    s_cbranch_vccz L_AT_R3
    s_add_u32 s82, s82, 1
    s_cmp_gt_u32 s82, 131072
    s_cbranch_scc1 L_AT_R3
    s_mov_b32 s90, 131072
    buffer_load_dwordx4 v[60:63], v59, s[20:23], s90 offen sc1
    s_waitcnt vmcnt(0)
    s_branch L_AT_R1
L_AT_R3:
    v_permlane16_swap_b32 v238, v240
    v_permlane16_swap_b32 v239, v241
    v_mul_f32 v68, 0x3acccccd, v60
    v_mul_f32 v69, 0x3acccccd, v61
    v_fma_f32 v69, -v68, v68, v69
    v_max_f32 v69, 0, v69
    v_cvt_pk_bf16_f32 v66, v68, v68
    v_and_b32 v66, 0xffff0000, v66
    v_cvt_pk_bf16_f32 v70, v69, v69
    v_and_b32 v70, 0xffff0000, v70
    v_add_f32 v70, 0x3727c5ac, v70
    v_cvt_pk_bf16_f32 v70, v70, v70
    v_and_b32 v70, 0xffff0000, v70
    v_sqrt_f32 v67, v70
    s_nop 0
    v_cvt_pk_bf16_f32 v67, v67, v67
    v_and_b32 v67, 0xffff0000, v67
    v_rcp_f32 v67, v67
    v_lshlrev_b32 v68, 16, v238
    v_lshlrev_b32 v72, 16, v239
    v_lshlrev_b32 v76, 16, v240
    v_lshlrev_b32 v80, 16, v241
    v_lshlrev_b32 v84, 16, v242
    v_lshlrev_b32 v88, 16, v243
    v_and_b32 v69, 0xffff0000, v238
    v_and_b32 v73, 0xffff0000, v239
    v_and_b32 v77, 0xffff0000, v240
    v_and_b32 v81, 0xffff0000, v241
    v_and_b32 v85, 0xffff0000, v242
    v_and_b32 v89, 0xffff0000, v243
    v_sub_f32 v70, v68, v66
    v_sub_f32 v74, v72, v66
    v_sub_f32 v78, v76, v66
    v_sub_f32 v82, v80, v66
    v_sub_f32 v86, v84, v66
    v_sub_f32 v90, v88, v66
    v_sub_f32 v71, v69, v66
    v_sub_f32 v75, v73, v66
    v_sub_f32 v79, v77, v66
    v_sub_f32 v83, v81, v66
    v_sub_f32 v87, v85, v66
    v_sub_f32 v91, v89, v66
    v_cvt_pk_bf16_f32 v71, v70, v71
    v_cvt_pk_bf16_f32 v75, v74, v75
    v_cvt_pk_bf16_f32 v79, v78, v79
    v_cvt_pk_bf16_f32 v83, v82, v83
    v_cvt_pk_bf16_f32 v87, v86, v87
    v_cvt_pk_bf16_f32 v91, v90, v91
    v_lshlrev_b32 v70, 16, v71
    v_lshlrev_b32 v74, 16, v75
    v_lshlrev_b32 v78, 16, v79
    v_lshlrev_b32 v82, 16, v83
    v_lshlrev_b32 v86, 16, v87
    v_lshlrev_b32 v90, 16, v91
    v_and_b32 v71, 0xffff0000, v71
    v_and_b32 v75, 0xffff0000, v75
    v_and_b32 v79, 0xffff0000, v79
    v_and_b32 v83, 0xffff0000, v83
    v_and_b32 v87, 0xffff0000, v87
    v_and_b32 v91, 0xffff0000, v91
    v_mul_f32 v70, v70, v67
    v_mul_f32 v74, v74, v67
    v_mul_f32 v78, v78, v67
    v_mul_f32 v82, v82, v67
    v_mul_f32 v86, v86, v67
    v_mul_f32 v90, v90, v67
    v_mul_f32 v71, v71, v67
    v_mul_f32 v75, v75, v67
    v_mul_f32 v79, v79, v67
    v_mul_f32 v83, v83, v67
    v_mul_f32 v87, v87, v67
    v_mul_f32 v91, v91, v67
    v_cvt_pk_bf16_f32 v71, v70, v71
    v_cvt_pk_bf16_f32 v75, v74, v75
    v_cvt_pk_bf16_f32 v79, v78, v79
    v_cvt_pk_bf16_f32 v83, v82, v83
    v_cvt_pk_bf16_f32 v87, v86, v87
    v_cvt_pk_bf16_f32 v91, v90, v91
    v_lshlrev_b32 v70, 16, v71
    v_lshlrev_b32 v74, 16, v75
    v_lshlrev_b32 v78, 16, v79
    v_lshlrev_b32 v82, 16, v83
    v_lshlrev_b32 v86, 16, v87
    v_lshlrev_b32 v90, 16, v91
    v_and_b32 v71, 0xffff0000, v71
    v_and_b32 v75, 0xffff0000, v75
    v_and_b32 v79, 0xffff0000, v79
    v_and_b32 v83, 0xffff0000, v83
    v_and_b32 v87, 0xffff0000, v87
    v_and_b32 v91, 0xffff0000, v91
    v_add_f32 v68, v68, v70
    v_add_f32 v72, v72, v74
    v_add_f32 v76, v76, v78
    v_add_f32 v80, v80, v82
    v_add_f32 v84, v84, v86
    v_add_f32 v88, v88, v90
    v_add_f32 v69, v69, v71
    v_add_f32 v73, v73, v75
    v_add_f32 v77, v77, v79
    v_add_f32 v81, v81, v83
    v_add_f32 v85, v85, v87
    v_add_f32 v89, v89, v91
    v_cvt_pk_bf16_f32 v238, v68, v69
    v_cvt_pk_bf16_f32 v239, v72, v73
    v_cvt_pk_bf16_f32 v240, v76, v77
    v_cvt_pk_bf16_f32 v241, v80, v81
    v_cvt_pk_bf16_f32 v242, v84, v85
    v_cvt_pk_bf16_f32 v243, v88, v89
L_AT_R2:
    s_cmp_lg_u32 s6, 0
    s_cbranch_scc1 L_AT_D
    s_cmp_lg_u32 s3, 0
    s_cbranch_scc1 L_AT_P1
    s_mul_i32 s83, s39, 80
    s_add_u32 s83, s83, 1116160
    v_min_u32 v152, 19, v253
    v_lshlrev_b32 v152, 2, v152
    s_mov_b32 s82, 0
WI_7:
    buffer_load_dword v153, v152, s[20:23], s83 offen sc1
    s_add_u32 s82, s82, 1
    s_cmp_gt_u32 s82, 131072
    s_cbranch_scc1 WIX_8
    s_waitcnt vmcnt(0)
    v_cmp_ne_u32 vcc, s45, v153
    s_nop 0
    s_cbranch_vccz WIX_8
    s_sleep 8
    s_branch WI_7
WIX_8:
    s_waitcnt vmcnt(0)
    s_branch L_AT_D
L_AT_P1:
    s_and_b32 s83, s2, 15
    s_mul_i32 s83, s83, 512
    s_add_u32 s83, s83, 32960
    v_lshrrev_b32 v152, 3, v253
    v_lshlrev_b32 v157, 2, v152
    v_mul_u32_u24 v153, 80, v152
    v_and_b32 v152, 7, v253
    v_min_u32 v152, 4, v152
    v_lshl_add_u32 v153, v152, 3, v153
    s_lshr_b32 s84, s36, 1
    s_mul_i32 s84, s84, 640
    s_and_b32 s85, s36, 1
    s_mul_i32 s85, s85, 40
    s_add_u32 s84, s84, s85
    s_add_u32 s84, s84, 262144
    s_add_u32 s85, s84, 10240
    s_add_u32 s86, s84, 20480
    s_mov_b32 s82, 0
L_AT_PL:
    buffer_load_dword v0, v157, s[20:23], s83 offen sc1
    buffer_load_dwordx2 v[2:3], v153, s[20:23], s84 offen sc1
    buffer_load_dwordx2 v[4:5], v153, s[20:23], s85 offen sc1
    buffer_load_dwordx2 v[6:7], v153, s[20:23], s86 offen sc1
    s_add_u32 s82, s82, 1
    s_waitcnt vmcnt(0)
    v_min3_u32 v154, v0, v2, v3
    v_min3_u32 v154, v154, v4, v5
    v_min3_u32 v154, v154, v6, v7
    v_cmp_eq_u32 vcc, 0, v154
    s_nop 0
    s_cbranch_vccz L_AT_PX
    s_cmp_gt_u32 s82, 131072
    s_cbranch_scc1 L_AT_PX
    s_sleep 2
    s_branch L_AT_PL
L_AT_PX:
    s_lshl_b32 s83, s37, 8
    s_sub_u32 s83, 256, s83
    v_add_u32 v157, 159744, v157
    v_and_b32 v0, 0x7ff, v0
    v_sub_u32 v0, 2047, v0
    ds_write_b32 v157, v0
    v_add_u32 v1, s83, v0
    v_lshlrev_b32 v153, 3, v1
    v_lshl_add_u32 v154, v152, 12, v153
    v_lshl_add_u32 v155, v152, 11, v153
    v_lshrrev_b32 v153, 3, v1
    v_mul_u32_u24 v153, 336, v153
    v_lshl_add_u32 v153, v152, 6, v153
    v_and_b32 v152, 7, v1
    v_lshl_add_u32 v153, v152, 1, v153
L_AT_D:
    s_waitcnt vmcnt(0) lgkmcnt(0)
    s_barrier
    s_cmp_eq_u32 s3, 0
    s_cbranch_scc1 L_AT_GO
    s_cmp_lg_u32 s6, 0
    s_cbranch_scc1 L_AT_P2
    v_mov_b32 v152, 0x200
    v_cmp_gt_u32 vcc, v152, v1
    s_nop 0
    s_mov_b64 exec, vcc
    ds_write_b64 v154, v[4:5] offset:0
    ds_write_b16 v153, v6 offset:34816
    ds_write_b16_d16_hi v153, v6 offset:34832
    ds_write_b16 v153, v7 offset:34848
    ds_write_b16_d16_hi v153, v7 offset:34864
    v_mov_b32 v152, 0xff
    v_cmp_lt_u32 vcc, v152, v1
    s_nop 0
    s_and_b64 exec, exec, vcc
    ds_write_b64 v155, v[2:3] offset:22528
    s_mov_b64 exec, -1
    s_waitcnt lgkmcnt(0)
L_AT_P2:
    s_barrier
L_AT_GO:
    s_sub_u32 s91, s6, 1
    s_cmp_lt_u32 s91, 4
    s_cbranch_scc1 L_WP_XL
    s_and_b32 s91, s91, 3
    s_mul_i32 s91, s91, 25600
    s_add_u32 s91, s91, 0
    s_mul_i32 s88, s39, 102400
    s_add_u32 s88, s88, s91
    s_add_u32 s88, s88, 1179648
    s_add_u32 m0, s91, 57344
    v_lshlrev_b32 v155, 4, v253
    buffer_load_dwordx4 v155, s[20:23], s88 offen offset:0 sc1 lds
    buffer_load_dwordx4 v155, s[20:23], s88 offen offset:1024 sc1 lds
    buffer_load_dwordx4 v155, s[20:23], s88 offen offset:2048 sc1 lds
    buffer_load_dwordx4 v155, s[20:23], s88 offen offset:3072 sc1 lds
    s_add_u32 m0, m0, 4096
    s_add_u32 s88, s88, 4096
    buffer_load_dwordx4 v155, s[20:23], s88 offen offset:0 sc1 lds
    buffer_load_dwordx4 v155, s[20:23], s88 offen offset:1024 sc1 lds
    buffer_load_dwordx4 v155, s[20:23], s88 offen offset:2048 sc1 lds
    buffer_load_dwordx4 v155, s[20:23], s88 offen offset:3072 sc1 lds
    s_add_u32 m0, m0, 4096
    s_add_u32 s88, s88, 4096
    buffer_load_dwordx4 v155, s[20:23], s88 offen offset:0 sc1 lds
    buffer_load_dwordx4 v155, s[20:23], s88 offen offset:1024 sc1 lds
    buffer_load_dwordx4 v155, s[20:23], s88 offen offset:2048 sc1 lds
    buffer_load_dwordx4 v155, s[20:23], s88 offen offset:3072 sc1 lds
    s_add_u32 m0, m0, 4096
    s_add_u32 s88, s88, 4096
L_WP_XL:
    v_mov_b32 v56, 0xff800000
    s_mov_b32 s87, 0
    s_sub_u32 s91, s6, 1
    s_cmp_ge_u32 s91, 4
    s_cbranch_scc1 L_AT_RUN
    s_setprio 1
L_AT_RUN:
    v_lshl_add_u32 v152, v149, 12, v147
    ds_read_b64 v[0:1], v152
    ds_read_b64 v[2:3], v152 offset:2048
    ds_read_b64 v[4:5], v147 offset:8192
    ds_read_b64 v[8:9], v144 offset:0
    ds_read_b64 v[10:11], v144 offset:4096
    ds_read_b64 v[12:13], v145 offset:0
    ds_read_b64 v[14:15], v144 offset:2048
    ds_read_b64 v[16:17], v144 offset:6144
    ds_read_b64 v[18:19], v145 offset:2048
    ds_read_b64 v[20:21], v144 offset:256
    ds_read_b64 v[22:23], v144 offset:4352
    ds_read_b64 v[24:25], v145 offset:256
    ds_read_b64 v[26:27], v144 offset:512
    ds_read_b64 v[28:29], v144 offset:4608
    ds_read_b64 v[30:31], v145 offset:512
    v_cmp_eq_u32 vcc, 0, v149
    v_mov_b32 v152, 0x3f80
    s_waitcnt lgkmcnt(9)
    v_cndmask_b32 v4, v152, v4, vcc
    v_cndmask_b32 v5, 0, v5, vcc
    v_mfma_f32_32x32x16_bf16 v[64:79], v[8:11], v[0:3], 0
    s_nop 0
    v_mfma_f32_32x32x8_bf16 v[64:79], v[12:13], v[4:5], v[64:79]
    s_waitcnt lgkmcnt(6)
    v_mfma_f32_32x32x16_bf16 v[96:111], v[14:17], v[0:3], 0
    v_mfma_f32_32x32x8_bf16 v[96:111], v[18:19], v[4:5], v[96:111]
    ds_read_b128 v[32:35], v146 offset:0
    ds_read_b128 v[36:39], v146 offset:672
    ds_read_b128 v[40:43], v146 offset:10752
    ds_read_b128 v[44:47], v146 offset:11424
    s_cmp_lg_u32 s3, 0
    s_nop 2
    s_cbranch_scc1 TO_9
    s_cmp_ge_u32 s6, 7
    s_cbranch_scc1 TO_9
    buffer_load_dword v246, v158, s[92:95], 0 offen
TO_9:
    ds_read_b64 v[8:9], v144 offset:768
    ds_read_b64 v[10:11], v144 offset:4864
    ds_read_b64 v[12:13], v145 offset:768
    v_cndmask_b32 v96, v64, v96, s[50:51]
    v_cndmask_b32 v97, v65, v97, s[52:53]
    v_cndmask_b32 v98, v66, v98, s[54:55]
    v_cndmask_b32 v99, v67, v99, s[56:57]
    v_cndmask_b32 v100, v68, v100, s[58:59]
    v_cndmask_b32 v101, v69, v101, s[60:61]
    v_cndmask_b32 v102, v70, v102, s[62:63]
    v_cndmask_b32 v103, v71, v103, s[64:65]
    v_cndmask_b32 v104, v72, v104, s[66:67]
    v_cndmask_b32 v105, v73, v105, s[68:69]
    v_cndmask_b32 v106, v74, v106, s[70:71]
    v_cndmask_b32 v107, v75, v107, s[72:73]
    v_cndmask_b32 v108, v76, v108, s[74:75]
    v_cndmask_b32 v109, v77, v109, s[76:77]
    v_cndmask_b32 v110, v78, v110, s[78:79]
    v_cndmask_b32 v111, v79, v111, s[80:81]
    v_max_f32 v150, v96, v97
    v_max_f32 v151, v98, v99
    v_max3_f32 v150, v150, v100, v101
    v_max3_f32 v151, v151, v102, v103
    v_max3_f32 v150, v150, v104, v105
    v_max3_f32 v151, v151, v106, v107
    v_max3_f32 v150, v150, v108, v109
    v_max3_f32 v151, v151, v110, v111
    v_max3_f32 v150, v150, v151, v56
    v_mov_b32 v151, v150
    s_nop 1
    v_permlane32_swap_b32 v150, v151
    v_max_f32 v150, v150, v151
    v_sub_f32 v112, 0, v150
    v_sub_f32 v113, 0, v150
    v_sub_f32 v114, 0, v150
    v_sub_f32 v115, 0, v150
    v_sub_f32 v116, 0, v150
    v_sub_f32 v117, 0, v150
    v_sub_f32 v118, 0, v150
    v_sub_f32 v119, 0, v150
    v_sub_f32 v120, 0, v150
    v_sub_f32 v121, 0, v150
    v_sub_f32 v122, 0, v150
    v_sub_f32 v123, 0, v150
    v_sub_f32 v124, 0, v150
    v_sub_f32 v125, 0, v150
    v_sub_f32 v126, 0, v150
    v_sub_f32 v127, 0, v150
    s_waitcnt lgkmcnt(0)
    s_nop 0
    v_mfma_f32_32x32x16_bf16 v[64:79], v[20:23], v[0:3], v[112:127]
    v_sub_f32 v96, v96, v150
    v_sub_f32 v97, v97, v150
    v_sub_f32 v98, v98, v150
    v_sub_f32 v99, v99, v150
    v_sub_f32 v100, v100, v150
    v_sub_f32 v101, v101, v150
    v_sub_f32 v102, v102, v150
    v_sub_f32 v103, v103, v150
    v_mfma_f32_32x32x8_bf16 v[64:79], v[24:25], v[4:5], v[64:79]
    v_sub_f32 v104, v104, v150
    v_sub_f32 v105, v105, v150
    v_sub_f32 v106, v106, v150
    v_sub_f32 v107, v107, v150
    v_sub_f32 v108, v108, v150
    v_sub_f32 v109, v109, v150
    v_sub_f32 v110, v110, v150
    v_sub_f32 v111, v111, v150
    ds_read_b64 v[14:15], v144 offset:1024
    v_exp_f32 v96, v96
    v_exp_f32 v97, v97
    v_exp_f32 v98, v98
    v_exp_f32 v99, v99
    v_exp_f32 v100, v100
    v_exp_f32 v101, v101
    v_exp_f32 v102, v102
    v_exp_f32 v103, v103
    ds_read_b64 v[16:17], v144 offset:5120
    v_exp_f32 v104, v104
    v_exp_f32 v105, v105
    v_exp_f32 v106, v106
    v_exp_f32 v107, v107
    v_exp_f32 v108, v108
    v_exp_f32 v109, v109
    v_exp_f32 v110, v110
    v_exp_f32 v111, v111
    ds_read_b64 v[18:19], v145 offset:1024
    v_cvt_pk_bf16_f32 v96, v96, v97
    v_cvt_pk_bf16_f32 v97, v98, v99
    v_cvt_pk_bf16_f32 v98, v100, v101
    v_cvt_pk_bf16_f32 v99, v102, v103
    v_cvt_pk_bf16_f32 v100, v104, v105
    v_cvt_pk_bf16_f32 v101, v106, v107
    v_cvt_pk_bf16_f32 v102, v108, v109
    v_cvt_pk_bf16_f32 v103, v110, v111
    v_mfma_f32_32x32x16_bf16 v[80:95], v[26:29], v[0:3], v[112:127]
    v_and_b32 v104, v48, v96
    v_and_b32 v105, v49, v97
    v_and_b32 v106, v50, v98
    v_and_b32 v107, v51, v99
    v_and_b32 v108, v52, v100
    v_and_b32 v109, v53, v101
    v_and_b32 v110, v54, v102
    v_and_b32 v111, v55, v103
    v_mfma_f32_32x32x8_bf16 v[80:95], v[30:31], v[4:5], v[80:95]
    v_bfi_b32 v96, v48, 0, v96
    v_bfi_b32 v97, v49, 0, v97
    v_bfi_b32 v98, v50, 0, v98
    v_bfi_b32 v99, v51, 0, v99
    v_bfi_b32 v100, v52, 0, v100
    v_bfi_b32 v101, v53, 0, v101
    v_bfi_b32 v102, v54, 0, v102
    v_bfi_b32 v103, v55, 0, v103
    v_mfma_f32_32x32x16_bf16 v[128:143], v[40:43], v[104:107], 0
    v_exp_f32 v64, v64
    v_exp_f32 v65, v65
    v_exp_f32 v66, v66
    v_exp_f32 v67, v67
    v_exp_f32 v68, v68
    v_mfma_f32_32x32x16_bf16 v[128:143], v[44:47], v[108:111], v[128:143]
    v_exp_f32 v69, v69
    v_exp_f32 v70, v70
    v_exp_f32 v71, v71
    v_exp_f32 v72, v72
    v_exp_f32 v73, v73
    v_mfma_f32_32x32x16_bf16 v[128:143], v[32:35], v[96:99], v[128:143]
    v_exp_f32 v74, v74
    v_exp_f32 v75, v75
    v_exp_f32 v76, v76
    v_exp_f32 v77, v77
    v_exp_f32 v78, v78
    v_mfma_f32_32x32x16_bf16 v[128:143], v[36:39], v[100:103], v[128:143]
    v_exp_f32 v79, v79
    v_cvt_pk_bf16_f32 v104, v64, v65
    v_cvt_pk_bf16_f32 v105, v66, v67
    v_cvt_pk_bf16_f32 v106, v68, v69
    v_cvt_pk_bf16_f32 v107, v70, v71
    ds_read_b128 v[32:35], v146 offset:1344
    ds_read_b128 v[36:39], v146 offset:2016
    v_cvt_pk_bf16_f32 v108, v72, v73
    v_cvt_pk_bf16_f32 v109, v74, v75
    v_cvt_pk_bf16_f32 v110, v76, v77
    v_cvt_pk_bf16_f32 v111, v78, v79
    s_waitcnt lgkmcnt(0)
    v_mfma_f32_32x32x16_bf16 v[64:79], v[8:11], v[0:3], v[112:127]
    v_exp_f32 v80, v80
    v_exp_f32 v81, v81
    ds_read_b128 v[40:43], v146 offset:2688
    v_exp_f32 v82, v82
    ds_read_b128 v[44:47], v146 offset:3360
    v_exp_f32 v83, v83
    v_exp_f32 v84, v84
    v_mfma_f32_32x32x8_bf16 v[64:79], v[12:13], v[4:5], v[64:79]
    v_exp_f32 v85, v85
    v_exp_f32 v86, v86
    ds_read_b64 v[20:21], v144 offset:1280
    v_exp_f32 v87, v87
    ds_read_b64 v[22:23], v144 offset:5376
    v_exp_f32 v88, v88
    v_exp_f32 v89, v89
    v_mfma_f32_32x32x16_bf16 v[128:143], v[32:35], v[104:107], v[128:143]
    v_exp_f32 v90, v90
    v_exp_f32 v91, v91
    ds_read_b64 v[24:25], v145 offset:1280
    v_exp_f32 v92, v92
    v_exp_f32 v93, v93
    v_exp_f32 v94, v94
    v_mfma_f32_32x32x16_bf16 v[128:143], v[36:39], v[108:111], v[128:143]
    v_exp_f32 v95, v95
    v_cvt_pk_bf16_f32 v96, v80, v81
    v_cvt_pk_bf16_f32 v97, v82, v83
    v_cvt_pk_bf16_f32 v98, v84, v85
    v_cvt_pk_bf16_f32 v99, v86, v87
    v_cvt_pk_bf16_f32 v100, v88, v89
    v_cvt_pk_bf16_f32 v101, v90, v91
    v_cvt_pk_bf16_f32 v102, v92, v93
    v_cvt_pk_bf16_f32 v103, v94, v95
    s_waitcnt lgkmcnt(0)
    v_mfma_f32_32x32x16_bf16 v[80:95], v[14:17], v[0:3], v[112:127]
    v_exp_f32 v64, v64
    v_exp_f32 v65, v65
    ds_read_b128 v[32:35], v146 offset:4032
    v_exp_f32 v66, v66
    ds_read_b128 v[36:39], v146 offset:4704
    v_exp_f32 v67, v67
    v_exp_f32 v68, v68
    v_mfma_f32_32x32x8_bf16 v[80:95], v[18:19], v[4:5], v[80:95]
    v_exp_f32 v69, v69
    v_exp_f32 v70, v70
    ds_read_b64 v[26:27], v144 offset:1536
    v_exp_f32 v71, v71
    ds_read_b64 v[28:29], v144 offset:5632
    v_exp_f32 v72, v72
    v_exp_f32 v73, v73
    v_mfma_f32_32x32x16_bf16 v[128:143], v[40:43], v[96:99], v[128:143]
    v_exp_f32 v74, v74
    v_exp_f32 v75, v75
    ds_read_b64 v[30:31], v145 offset:1536
    v_exp_f32 v76, v76
    v_exp_f32 v77, v77
    v_exp_f32 v78, v78
    v_mfma_f32_32x32x16_bf16 v[128:143], v[44:47], v[100:103], v[128:143]
    v_exp_f32 v79, v79
    v_cvt_pk_bf16_f32 v104, v64, v65
    v_cvt_pk_bf16_f32 v105, v66, v67
    v_cvt_pk_bf16_f32 v106, v68, v69
    v_cvt_pk_bf16_f32 v107, v70, v71
    v_cvt_pk_bf16_f32 v108, v72, v73
    v_cvt_pk_bf16_f32 v109, v74, v75
    v_cvt_pk_bf16_f32 v110, v76, v77
    v_cvt_pk_bf16_f32 v111, v78, v79
    s_waitcnt lgkmcnt(0)
    v_mfma_f32_32x32x16_bf16 v[64:79], v[20:23], v[0:3], v[112:127]
    v_exp_f32 v80, v80
    v_exp_f32 v81, v81
    ds_read_b128 v[40:43], v146 offset:5376
    v_exp_f32 v82, v82
    ds_read_b128 v[44:47], v146 offset:6048
    v_exp_f32 v83, v83
    v_exp_f32 v84, v84
    v_mfma_f32_32x32x8_bf16 v[64:79], v[24:25], v[4:5], v[64:79]
    v_exp_f32 v85, v85
    v_exp_f32 v86, v86
    ds_read_b64 v[8:9], v144 offset:1792
    v_exp_f32 v87, v87
    ds_read_b64 v[10:11], v144 offset:5888
    v_exp_f32 v88, v88
    v_exp_f32 v89, v89
    v_mfma_f32_32x32x16_bf16 v[128:143], v[32:35], v[104:107], v[128:143]
    v_exp_f32 v90, v90
    v_exp_f32 v91, v91
    ds_read_b64 v[12:13], v145 offset:1792
    v_exp_f32 v92, v92
    v_exp_f32 v93, v93
    v_exp_f32 v94, v94
    v_mfma_f32_32x32x16_bf16 v[128:143], v[36:39], v[108:111], v[128:143]
    v_exp_f32 v95, v95
    v_cvt_pk_bf16_f32 v96, v80, v81
    v_cvt_pk_bf16_f32 v97, v82, v83
    v_cvt_pk_bf16_f32 v98, v84, v85
    v_cvt_pk_bf16_f32 v99, v86, v87
    v_cvt_pk_bf16_f32 v100, v88, v89
    v_cvt_pk_bf16_f32 v101, v90, v91
    v_cvt_pk_bf16_f32 v102, v92, v93
    v_cvt_pk_bf16_f32 v103, v94, v95
    s_waitcnt lgkmcnt(0)
    v_mfma_f32_32x32x16_bf16 v[80:95], v[26:29], v[0:3], v[112:127]
    v_exp_f32 v64, v64
    v_exp_f32 v65, v65
    ds_read_b128 v[32:35], v146 offset:6720
    v_exp_f32 v66, v66
    ds_read_b128 v[36:39], v146 offset:7392
    v_exp_f32 v67, v67
    v_exp_f32 v68, v68
    v_mfma_f32_32x32x8_bf16 v[80:95], v[30:31], v[4:5], v[80:95]
    v_exp_f32 v69, v69
    v_exp_f32 v70, v70
    v_exp_f32 v71, v71
    v_exp_f32 v72, v72
    v_exp_f32 v73, v73
    v_mfma_f32_32x32x16_bf16 v[128:143], v[40:43], v[96:99], v[128:143]
    v_exp_f32 v74, v74
    v_exp_f32 v75, v75
    v_exp_f32 v76, v76
    v_exp_f32 v77, v77
    v_exp_f32 v78, v78
    v_mfma_f32_32x32x16_bf16 v[128:143], v[44:47], v[100:103], v[128:143]
    v_exp_f32 v79, v79
    v_cvt_pk_bf16_f32 v104, v64, v65
    v_cvt_pk_bf16_f32 v105, v66, v67
    v_cvt_pk_bf16_f32 v106, v68, v69
    v_cvt_pk_bf16_f32 v107, v70, v71
    v_cvt_pk_bf16_f32 v108, v72, v73
    v_cvt_pk_bf16_f32 v109, v74, v75
    v_cvt_pk_bf16_f32 v110, v76, v77
    v_cvt_pk_bf16_f32 v111, v78, v79
    s_waitcnt lgkmcnt(0)
    v_mfma_f32_32x32x16_bf16 v[64:79], v[8:11], v[0:3], v[112:127]
    v_exp_f32 v80, v80
    v_exp_f32 v81, v81
    ds_read_b128 v[40:43], v146 offset:8064
    v_exp_f32 v82, v82
    ds_read_b128 v[44:47], v146 offset:8736
    v_exp_f32 v83, v83
    v_exp_f32 v84, v84
    v_mfma_f32_32x32x8_bf16 v[64:79], v[12:13], v[4:5], v[64:79]
    v_exp_f32 v85, v85
    v_exp_f32 v86, v86
    v_exp_f32 v87, v87
    v_exp_f32 v88, v88
    v_exp_f32 v89, v89
    v_mfma_f32_32x32x16_bf16 v[128:143], v[32:35], v[104:107], v[128:143]
    v_exp_f32 v90, v90
    v_exp_f32 v91, v91
    v_exp_f32 v92, v92
    v_exp_f32 v93, v93
    v_exp_f32 v94, v94
    v_mfma_f32_32x32x16_bf16 v[128:143], v[36:39], v[108:111], v[128:143]
    v_exp_f32 v95, v95
    v_cvt_pk_bf16_f32 v96, v80, v81
    v_cvt_pk_bf16_f32 v97, v82, v83
    v_cvt_pk_bf16_f32 v98, v84, v85
    v_cvt_pk_bf16_f32 v99, v86, v87
    v_cvt_pk_bf16_f32 v100, v88, v89
    v_cvt_pk_bf16_f32 v101, v90, v91
    v_cvt_pk_bf16_f32 v102, v92, v93
    v_cvt_pk_bf16_f32 v103, v94, v95
    s_waitcnt lgkmcnt(0)
    v_mfma_f32_32x32x16_bf16 v[128:143], v[40:43], v[96:99], v[128:143]
    v_exp_f32 v64, v64
    v_exp_f32 v65, v65
    ds_read_b128 v[32:35], v146 offset:9408
    v_exp_f32 v66, v66
    ds_read_b128 v[36:39], v146 offset:10080
    v_exp_f32 v67, v67
    v_exp_f32 v68, v68
    v_exp_f32 v69, v69
    v_exp_f32 v70, v70
    v_exp_f32 v71, v71
    v_exp_f32 v72, v72
    v_exp_f32 v73, v73
    v_mfma_f32_32x32x16_bf16 v[128:143], v[44:47], v[100:103], v[128:143]
    v_exp_f32 v74, v74
    v_exp_f32 v75, v75
    v_exp_f32 v76, v76
    v_exp_f32 v77, v77
    v_exp_f32 v78, v78
    v_exp_f32 v79, v79
    v_cvt_pk_bf16_f32 v104, v64, v65
    v_cvt_pk_bf16_f32 v105, v66, v67
    v_cvt_pk_bf16_f32 v106, v68, v69
    v_cvt_pk_bf16_f32 v107, v70, v71
    v_cvt_pk_bf16_f32 v108, v72, v73
    v_cvt_pk_bf16_f32 v109, v74, v75
    v_cvt_pk_bf16_f32 v110, v76, v77
    v_cvt_pk_bf16_f32 v111, v78, v79
    s_waitcnt lgkmcnt(0)
    v_mfma_f32_32x32x16_bf16 v[128:143], v[32:35], v[104:107], v[128:143]
    v_mfma_f32_32x32x16_bf16 v[128:143], v[36:39], v[108:111], v[128:143]
    v_mov_b32 v155, 0x5d800000
    s_nop 10
    v_rcp_f32 v154, v140
    v_cmp_nlt_f32 vcc, v140, v155
    s_nop 0
    s_cbranch_vccnz L_AT_FB
L_AT_OUT:
    v_mul_f32 v128, v154, v128
    v_mul_f32 v129, v154, v129
    v_mul_f32 v130, v154, v130
    v_mul_f32 v131, v154, v131
    v_mul_f32 v132, v154, v132
    v_mul_f32 v133, v154, v133
    v_mul_f32 v134, v154, v134
    v_mul_f32 v135, v154, v135
    v_mul_f32 v136, v154, v136
    v_mul_f32 v137, v154, v137
    v_mul_f32 v138, v154, v138
    v_mul_f32 v139, v154, v139
    v_cvt_pk_bf16_f32 v64, v128, v129
    v_cvt_pk_bf16_f32 v65, v130, v131
    v_cvt_pk_bf16_f32 v66, v132, v133
    v_cvt_pk_bf16_f32 v67, v134, v135
    v_cvt_pk_bf16_f32 v68, v136, v137
    v_cvt_pk_bf16_f32 v69, v138, v139
    v_min_u32 v64, -2, v64
    v_min_u32 v65, -2, v65
    v_min_u32 v66, -2, v66
    v_min_u32 v67, -2, v67
    v_min_u32 v68, -2, v68
    v_min_u32 v69, -2, v69
    buffer_store_dwordx4 v[64:67], v57, s[20:23], s4 offen sc1
    s_mov_b32 exec_hi, 0
    buffer_store_dwordx2 v[68:69], v58, s[20:23], s5 offen sc1
    s_mov_b64 exec, -1
    s_setprio 0
    s_sub_u32 s91, s6, 1
    s_cmp_ge_u32 s91, 4
    s_cbranch_scc1 L_WP_XE
    s_and_b32 s91, s91, 3
    s_mul_i32 s91, s91, 25600
    s_add_u32 s91, s91, 12288
    s_mul_i32 s88, s39, 102400
    s_add_u32 s88, s88, s91
    s_add_u32 s88, s88, 1179648
    s_add_u32 m0, s91, 57344
    v_lshlrev_b32 v155, 4, v253
    buffer_load_dwordx4 v155, s[20:23], s88 offen offset:0 sc1 lds
    buffer_load_dwordx4 v155, s[20:23], s88 offen offset:1024 sc1 lds
    buffer_load_dwordx4 v155, s[20:23], s88 offen offset:2048 sc1 lds
    buffer_load_dwordx4 v155, s[20:23], s88 offen offset:3072 sc1 lds
    s_add_u32 m0, m0, 4096
    s_add_u32 s88, s88, 4096
    buffer_load_dwordx4 v155, s[20:23], s88 offen offset:0 sc1 lds
    buffer_load_dwordx4 v155, s[20:23], s88 offen offset:1024 sc1 lds
    buffer_load_dwordx4 v155, s[20:23], s88 offen offset:2048 sc1 lds
    buffer_load_dwordx4 v155, s[20:23], s88 offen offset:3072 sc1 lds
    s_add_u32 m0, m0, 4096
    s_add_u32 s88, s88, 4096
    buffer_load_dwordx4 v155, s[20:23], s88 offen offset:0 sc1 lds
    buffer_load_dwordx4 v155, s[20:23], s88 offen offset:1024 sc1 lds
    buffer_load_dwordx4 v155, s[20:23], s88 offen offset:2048 sc1 lds
    buffer_load_dwordx4 v155, s[20:23], s88 offen offset:3072 sc1 lds
    s_add_u32 m0, m0, 4096
    s_add_u32 s88, s88, 4096
    buffer_load_dwordx4 v155, s[20:23], s88 offen offset:0 sc1 lds
    s_waitcnt vmcnt(0)
L_WP_XE:
    s_lshl_b32 s83, s37, 5
    v_add_u32 v152, s83, v253
    v_mul_u32_u24 v152, 512, v152
    v_mov_b32 v153, 1
    s_and_b32 s83, s36, 0
    s_lshl_b32 s83, s83, 7
    s_add_u32 s83, s83, s34
    s_add_u32 s83, s83, 4
    s_waitcnt vmcnt(2)
    s_barrier
    s_cmp_lg_u32 s6, 2
    s_cbranch_scc1 L_AT_END
    s_mov_b32 exec_hi, 0
    buffer_atomic_add v153, v152, s[20:23], s83 offen
    s_mov_b64 exec, 1
    s_cmp_lt_u32 s2, 192
    s_cbranch_scc1 L_AT_E2
    v_mov_b32 v154, 0
    v_mov_b32 v155, s45
    s_lshl_b32 s83, s2, 2
    s_add_u32 s83, s83, 1114368
    buffer_store_dword v155, v154, s[20:23], s83 offen sc1
L_AT_E2:
    s_mov_b64 exec, -1
    s_branch L_AT_END
L_AT_FB:
    s_cmp_lg_u32 s87, 0
    s_cbranch_scc1 L_AT_OUT
    s_mov_b32 s87, 1
    v_add_u32 v152, 256, v144
    v_add_u32 v153, 256, v145
L_AT_FL:
    ds_read_b64 v[8:9], v152
    ds_read_b64 v[10:11], v152 offset:4096
    ds_read_b64 v[12:13], v153
    v_add_u32 v152, 256, v152
    v_add_u32 v153, 256, v153
    s_waitcnt lgkmcnt(0)
    v_mfma_f32_32x32x16_bf16 v[64:79], v[8:11], v[0:3], 0
    v_mfma_f32_32x32x8_bf16 v[64:79], v[12:13], v[4:5], v[64:79]
    s_nop 11
    v_max3_f32 v56, v56, v64, v65
    v_max3_f32 v56, v56, v66, v67
    v_max3_f32 v56, v56, v68, v69
    v_max3_f32 v56, v56, v70, v71
    v_max3_f32 v56, v56, v72, v73
    v_max3_f32 v56, v56, v74, v75
    v_max3_f32 v56, v56, v76, v77
    v_max3_f32 v56, v56, v78, v79
    s_add_u32 s87, s87, 1
    s_cmp_lt_u32 s87, 8
    s_cbranch_scc1 L_AT_FL
    s_branch L_AT_RUN
L_AT_END:
    s_lshr_b32 s87, s6, 2
    s_and_b32 s88, s6, 3
    v_lshrrev_b32 v147, 4, v253
    v_and_b32 v148, 15, v253
    v_bfe_u32 v150, v253, 2, 4
    v_mul_u32_u24 v150, 160, v150
    v_and_b32 v151, 3, v253
    v_lshl_add_u32 v150, v151, 3, v150
    s_mul_i32 s84, s87, 51200
    s_add_u32 s84, s84, 57344
    v_add_u32 v146, s84, v150
    s_lshl_b32 s84, s87, 6
    v_add_u32 v144, s84, v146
    s_xor_b32 s84, s84, 64
    v_add_u32 v145, s84, v146
    v_mov_b32 v138, 0
    v_mov_b32 v140, 0
    v_mov_b32 v141, 0
    s_mov_b32 s58, 0
    s_cmp_eq_u32 s3, 0
    s_cbranch_scc1 L_WO_R3
    v_mov_b32 v136, 159744
    ds_read_b128 v[104:107], v136
    ds_read_b128 v[108:111], v136 offset:16
    v_mov_b32 v137, -1
    s_waitcnt lgkmcnt(0)
    v_cmp_ne_u32 s[50:51], v104, v244
    v_cmp_ne_u32 s[52:53], v105, v244
    v_cmp_ne_u32 s[54:55], v106, v244
    v_cmp_ne_u32 s[56:57], v107, v244
    v_cndmask_b32 v137, 0, v137, s[50:51]
    v_cndmask_b32 v137, 1, v137, s[52:53]
    v_cndmask_b32 v137, 2, v137, s[54:55]
    v_cndmask_b32 v137, 3, v137, s[56:57]
    v_cmp_ne_u32 s[50:51], v108, v244
    v_cmp_ne_u32 s[52:53], v109, v244
    v_cmp_ne_u32 s[54:55], v110, v244
    v_cmp_ne_u32 s[56:57], v111, v244
    v_cndmask_b32 v137, 4, v137, s[50:51]
    v_cndmask_b32 v137, 5, v137, s[52:53]
    v_cndmask_b32 v137, 6, v137, s[54:55]
    v_cndmask_b32 v137, 7, v137, s[56:57]
    v_cmp_ne_u32 s[50:51], -1, v137
    s_nop 0
    s_mov_b64 exec, s[50:51]
    s_cbranch_execz L_WO_R2B
    v_mul_u32_u24 v137, 80, v137
    s_mul_i32 s84, s39, 1280
    s_mul_i32 s85, s32, 10240
    s_add_u32 s84, s84, s85
    s_add_u32 s58, s84, 294912
    s_lshl_b32 s85, s87, 6
    v_lshl_add_u32 v138, v147, 3, s85
    v_mov_b32 v142, 560
    v_add_u32 v140, 32, v138
    v_cmp_lt_u32 vcc, 79, v138
    s_nop 1
    v_cndmask_b32 v139, 0, v142, vcc
    v_add3_u32 v138, v138, v139, v137
    v_cmp_lt_u32 vcc, 79, v140
    s_nop 1
    v_cndmask_b32 v139, 0, v142, vcc
    v_add3_u32 v140, v140, v139, v137
    v_lshl_add_u32 v141, v147, 3, v137
    buffer_load_dwordx2 v[128:129], v138, s[20:23], s58 offen sc1
    buffer_load_dwordx2 v[130:131], v140, s[20:23], s58 offen sc1
    buffer_load_dwordx2 v[132:133], v141, s[20:23], s58 offen offset:688 sc1
L_WO_R2B:
    s_mov_b64 exec, -1
    s_branch L_WO_R4
L_WO_R3:
L_WO_R4:
    s_lshl_b32 s83, s38, 2
    s_add_u32 s83, s83, s88
    s_mul_i32 s83, s83, 20480
    s_add_u32 s83, s83, s7
    s_add_u32 s83, s83, 10551296
    s_lshl_b32 s84, s87, 11
    s_add_u32 s92, s83, s84
    s_add_u32 s92, s92, 16384
    s_lshl_b32 s84, s87, 13
    s_add_u32 s90, s83, s84
    s_add_u32 s91, s90, 4096
    s_mov_b32 s93, 0
    s_mov_b32 s86, -1
    v_mov_b32 v248, 0
    v_lshlrev_b32 v152, 8, v147
    v_lshl_add_u32 v152, v148, 3, v152
    v_lshlrev_b32 v153, 4, v253
    ds_read_b64_tr_b16 v[40:41], v144 offset:0
    ds_read_b64_tr_b16 v[42:43], v144 offset:2560
    ds_read_b64_tr_b16 v[44:45], v144 offset:32
    ds_read_b64_tr_b16 v[46:47], v144 offset:2592
    ds_read_b64_tr_b16 v[48:49], v145 offset:0
    ds_read_b64_tr_b16 v[50:51], v145 offset:2560
    ds_read_b64_tr_b16 v[52:53], v145 offset:32
    ds_read_b64_tr_b16 v[54:55], v145 offset:2592
    ds_read_b64_tr_b16 v[56:57], v146 offset:128
    ds_read_b64_tr_b16 v[58:59], v146 offset:2688
    ds_read_b64_tr_b16 v[60:61], v144 offset:5120
    ds_read_b64_tr_b16 v[62:63], v144 offset:7680
    ds_read_b64_tr_b16 v[64:65], v144 offset:5152
    ds_read_b64_tr_b16 v[66:67], v144 offset:7712
    ds_read_b64_tr_b16 v[68:69], v145 offset:5120
    ds_read_b64_tr_b16 v[70:71], v145 offset:7680
    ds_read_b64_tr_b16 v[72:73], v145 offset:5152
    ds_read_b64_tr_b16 v[74:75], v145 offset:7712
    ds_read_b64_tr_b16 v[76:77], v146 offset:5248
    ds_read_b64_tr_b16 v[78:79], v146 offset:7808
    ds_read_b64_tr_b16 v[80:81], v144 offset:10240
    ds_read_b64_tr_b16 v[82:83], v144 offset:12800
    ds_read_b64_tr_b16 v[84:85], v144 offset:10272
    ds_read_b64_tr_b16 v[86:87], v144 offset:12832
    ds_read_b64_tr_b16 v[88:89], v145 offset:10240
    ds_read_b64_tr_b16 v[90:91], v145 offset:12800
    ds_read_b64_tr_b16 v[92:93], v145 offset:10272
    ds_read_b64_tr_b16 v[94:95], v145 offset:12832
    ds_read_b64_tr_b16 v[96:97], v146 offset:10368
    ds_read_b64_tr_b16 v[98:99], v146 offset:12928
    s_cmp_lg_u32 s6, 1
    s_cbranch_scc1 L_WO_W
    s_lshl_b32 s84, s38, 3
    s_add_u32 s84, s84, s39
    s_mul_i32 s84, s84, 512
    s_add_u32 s84, s84, s34
    s_add_u32 s84, s84, 4
    v_lshlrev_b32 v150, 7, v253
    s_mov_b32 exec_lo, 1
    s_mov_b32 exec_hi, 0
    s_mov_b32 s82, 0
POLL_10:
    buffer_load_dword v151, v150, s[20:23], s84 offen sc1
    s_add_u32 s82, s82, 1
    s_cmp_gt_u32 s82, 131072
    s_cbranch_scc1 POLLX_11
    s_waitcnt vmcnt(0)
    v_cmp_ne_u32 vcc, 32, v151
    s_nop 0
    s_cbranch_vccnz POLL_10
POLLX_11:
    s_waitcnt vmcnt(0)
    s_mov_b64 exec, -1
L_WO_W:
    s_barrier
L_WO_LD:
    buffer_load_dwordx4 v[0:3], v153, s[20:23], s90 offen offset:0 sc1
    buffer_load_dwordx4 v[4:7], v153, s[20:23], s90 offen offset:1024 sc1
    buffer_load_dwordx4 v[8:11], v153, s[20:23], s90 offen offset:2048 sc1
    buffer_load_dwordx4 v[12:15], v153, s[20:23], s90 offen offset:3072 sc1
    buffer_load_dwordx4 v[16:19], v153, s[20:23], s91 offen offset:0 sc1
    buffer_load_dwordx4 v[20:23], v153, s[20:23], s91 offen offset:1024 sc1
    buffer_load_dwordx4 v[24:27], v153, s[20:23], s91 offen offset:2048 sc1
    buffer_load_dwordx4 v[28:31], v153, s[20:23], s91 offen offset:3072 sc1
    buffer_load_dwordx2 v[32:33], v152, s[20:23], s92 offen offset:0 sc1
    buffer_load_dwordx2 v[34:35], v152, s[20:23], s92 offen offset:128 sc1
    buffer_load_dwordx2 v[36:37], v152, s[20:23], s92 offen offset:1024 sc1
    buffer_load_dwordx2 v[38:39], v152, s[20:23], s92 offen offset:1152 sc1
    v_mov_b32 v149, 0
    s_cmp_lg_u32 s93, 0
    s_cbranch_scc1 L_WO_MM
    s_cmp_eq_u32 s3, 0
    s_cbranch_scc1 L_WO_R5
    s_waitcnt vmcnt(12)
    s_mov_b64 exec, s[50:51]
    s_cbranch_execz L_WO_PX
    s_mov_b32 s82, 0
L_WO_PL:
    v_min3_u32 v136, v128, v129, v130
    v_min3_u32 v136, v136, v131, v132
    v_min_u32 v136, v136, v133
    v_cmp_eq_u32 vcc, 0, v136
    s_nop 0
    s_cbranch_vccz L_WO_PX
    s_add_u32 s82, s82, 1
    s_cmp_gt_u32 s82, 131072
    s_cbranch_scc1 L_WO_PX
    buffer_load_dwordx2 v[128:129], v138, s[20:23], s58 offen sc1
    buffer_load_dwordx2 v[130:131], v140, s[20:23], s58 offen sc1
    buffer_load_dwordx2 v[132:133], v141, s[20:23], s58 offen offset:688 sc1
    s_waitcnt vmcnt(0)
    s_branch L_WO_PL
L_WO_PX:
    s_mov_b64 exec, -1
    v_cndmask_b32 v238, v238, v128, s[50:51]
    v_cndmask_b32 v239, v239, v129, s[50:51]
    v_cndmask_b32 v240, v240, v130, s[50:51]
    v_cndmask_b32 v241, v241, v131, s[50:51]
    v_cndmask_b32 v242, v242, v132, s[50:51]
    v_cndmask_b32 v243, v243, v133, s[50:51]
L_WO_R5:
    s_lshr_b32 s83, s38, 1
    s_mul_i32 s83, s83, 8192
    s_add_u32 s83, s83, 20
    s_and_b32 s84, s39, 0
    s_lshl_b32 s84, s84, 7
    s_add_u32 s83, s83, s84
    s_mov_b32 s89, 0
    s_cmp_lt_u32 s41, 48
    s_cmov_b32 s89, 0x8000
    s_cmp_eq_u32 s3, 0
    s_cmov_b32 s89, 0xfff
    v_mul_u32_u24 v248, 512, v253
    v_add_u32 v248, s83, v248
    s_mul_i32 s83, s38, 512
    s_add_u32 s83, s83, 24
    v_writelane_b32 v248, s83, 15
    v_mov_b32 v249, 1
    v_lshlrev_b32 v120, 16, v238
    v_and_b32 v121, 0xffff0000, v238
    v_lshlrev_b32 v132, 16, v232
    v_and_b32 v133, 0xffff0000, v232
    v_lshlrev_b32 v122, 16, v239
    v_and_b32 v123, 0xffff0000, v239
    v_lshlrev_b32 v134, 16, v233
    v_and_b32 v135, 0xffff0000, v233
    v_lshlrev_b32 v124, 16, v240
    v_and_b32 v125, 0xffff0000, v240
    v_lshlrev_b32 v136, 16, v234
    v_and_b32 v137, 0xffff0000, v234
    v_lshlrev_b32 v126, 16, v241
    v_and_b32 v127, 0xffff0000, v241
    v_lshlrev_b32 v138, 16, v235
    v_and_b32 v139, 0xffff0000, v235
    v_lshlrev_b32 v128, 16, v242
    v_and_b32 v129, 0xffff0000, v242
    v_lshlrev_b32 v140, 16, v236
    v_and_b32 v141, 0xffff0000, v236
    v_lshlrev_b32 v130, 16, v243
    v_and_b32 v131, 0xffff0000, v243
    v_lshlrev_b32 v142, 16, v237
    v_and_b32 v143, 0xffff0000, v237
L_WO_MM:
    s_waitcnt vmcnt(11) lgkmcnt(15)
    v_mfma_f32_16x16x32_bf16 v[100:103], v[40:43], v[0:3], 0
    ds_read_b64_tr_b16 v[40:41], v144 offset:15360
    ds_read_b64_tr_b16 v[42:43], v144 offset:17920
    v_mfma_f32_16x16x32_bf16 v[104:107], v[44:47], v[0:3], 0
    ds_read_b64_tr_b16 v[44:45], v144 offset:15392
    ds_read_b64_tr_b16 v[46:47], v144 offset:17952
    v_mfma_f32_16x16x32_bf16 v[108:111], v[48:51], v[0:3], 0
    ds_read_b64_tr_b16 v[48:49], v145 offset:15360
    ds_read_b64_tr_b16 v[50:51], v145 offset:17920
    v_mfma_f32_16x16x32_bf16 v[112:115], v[52:55], v[0:3], 0
    ds_read_b64_tr_b16 v[52:53], v145 offset:15392
    ds_read_b64_tr_b16 v[54:55], v145 offset:17952
    v_max3_u32 v149, v149, v0, v1
    v_mfma_f32_16x16x32_bf16 v[116:119], v[56:59], v[0:3], 0
    ds_read_b64_tr_b16 v[56:57], v146 offset:15488
    ds_read_b64_tr_b16 v[58:59], v146 offset:18048
    v_max3_u32 v149, v149, v2, v3
    s_waitcnt vmcnt(10) lgkmcnt(15)
    v_mfma_f32_16x16x32_bf16 v[100:103], v[60:63], v[4:7], v[100:103]
    ds_read_b64_tr_b16 v[60:61], v144 offset:20480
    ds_read_b64_tr_b16 v[62:63], v144 offset:23040
    v_mfma_f32_16x16x32_bf16 v[104:107], v[64:67], v[4:7], v[104:107]
    ds_read_b64_tr_b16 v[64:65], v144 offset:20512
    ds_read_b64_tr_b16 v[66:67], v144 offset:23072
    v_mfma_f32_16x16x32_bf16 v[108:111], v[68:71], v[4:7], v[108:111]
    ds_read_b64_tr_b16 v[68:69], v145 offset:20480
    ds_read_b64_tr_b16 v[70:71], v145 offset:23040
    v_mfma_f32_16x16x32_bf16 v[112:115], v[72:75], v[4:7], v[112:115]
    ds_read_b64_tr_b16 v[72:73], v145 offset:20512
    ds_read_b64_tr_b16 v[74:75], v145 offset:23072
    v_max3_u32 v149, v149, v4, v5
    v_mfma_f32_16x16x32_bf16 v[116:119], v[76:79], v[4:7], v[116:119]
    ds_read_b64_tr_b16 v[76:77], v146 offset:20608
    ds_read_b64_tr_b16 v[78:79], v146 offset:23168
    v_max3_u32 v149, v149, v6, v7
    s_waitcnt vmcnt(9) lgkmcnt(15)
    v_mfma_f32_16x16x32_bf16 v[100:103], v[80:83], v[8:11], v[100:103]
    ds_read_b64_tr_b16 v[80:81], v144 offset:25600
    ds_read_b64_tr_b16 v[82:83], v144 offset:28160
    v_mfma_f32_16x16x32_bf16 v[104:107], v[84:87], v[8:11], v[104:107]
    ds_read_b64_tr_b16 v[84:85], v144 offset:25632
    ds_read_b64_tr_b16 v[86:87], v144 offset:28192
    v_mfma_f32_16x16x32_bf16 v[108:111], v[88:91], v[8:11], v[108:111]
    ds_read_b64_tr_b16 v[88:89], v145 offset:25600
    ds_read_b64_tr_b16 v[90:91], v145 offset:28160
    v_mfma_f32_16x16x32_bf16 v[112:115], v[92:95], v[8:11], v[112:115]
    ds_read_b64_tr_b16 v[92:93], v145 offset:25632
    ds_read_b64_tr_b16 v[94:95], v145 offset:28192
    v_max3_u32 v149, v149, v8, v9
    v_mfma_f32_16x16x32_bf16 v[116:119], v[96:99], v[8:11], v[116:119]
    ds_read_b64_tr_b16 v[96:97], v146 offset:25728
    ds_read_b64_tr_b16 v[98:99], v146 offset:28288
    v_max3_u32 v149, v149, v10, v11
    s_waitcnt vmcnt(8) lgkmcnt(15)
    v_mfma_f32_16x16x32_bf16 v[100:103], v[40:43], v[12:15], v[100:103]
    ds_read_b64_tr_b16 v[40:41], v144 offset:30720
    ds_read_b64_tr_b16 v[42:43], v144 offset:33280
    v_mfma_f32_16x16x32_bf16 v[104:107], v[44:47], v[12:15], v[104:107]
    ds_read_b64_tr_b16 v[44:45], v144 offset:30752
    ds_read_b64_tr_b16 v[46:47], v144 offset:33312
    v_mfma_f32_16x16x32_bf16 v[108:111], v[48:51], v[12:15], v[108:111]
    ds_read_b64_tr_b16 v[48:49], v145 offset:30720
    ds_read_b64_tr_b16 v[50:51], v145 offset:33280
    v_mfma_f32_16x16x32_bf16 v[112:115], v[52:55], v[12:15], v[112:115]
    ds_read_b64_tr_b16 v[52:53], v145 offset:30752
    ds_read_b64_tr_b16 v[54:55], v145 offset:33312
    v_max3_u32 v149, v149, v12, v13
    v_mfma_f32_16x16x32_bf16 v[116:119], v[56:59], v[12:15], v[116:119]
    ds_read_b64_tr_b16 v[56:57], v146 offset:30848
    ds_read_b64_tr_b16 v[58:59], v146 offset:33408
    v_max3_u32 v149, v149, v14, v15
    s_waitcnt vmcnt(7) lgkmcnt(15)
    v_mfma_f32_16x16x32_bf16 v[100:103], v[60:63], v[16:19], v[100:103]
    ds_read_b64_tr_b16 v[60:61], v144 offset:35840
    ds_read_b64_tr_b16 v[62:63], v144 offset:38400
    v_mfma_f32_16x16x32_bf16 v[104:107], v[64:67], v[16:19], v[104:107]
    ds_read_b64_tr_b16 v[64:65], v144 offset:35872
    ds_read_b64_tr_b16 v[66:67], v144 offset:38432
    v_mfma_f32_16x16x32_bf16 v[108:111], v[68:71], v[16:19], v[108:111]
    ds_read_b64_tr_b16 v[68:69], v145 offset:35840
    ds_read_b64_tr_b16 v[70:71], v145 offset:38400
    v_mfma_f32_16x16x32_bf16 v[112:115], v[72:75], v[16:19], v[112:115]
    ds_read_b64_tr_b16 v[72:73], v145 offset:35872
    ds_read_b64_tr_b16 v[74:75], v145 offset:38432
    v_max3_u32 v149, v149, v16, v17
    v_mfma_f32_16x16x32_bf16 v[116:119], v[76:79], v[16:19], v[116:119]
    ds_read_b64_tr_b16 v[76:77], v146 offset:35968
    ds_read_b64_tr_b16 v[78:79], v146 offset:38528
    v_max3_u32 v149, v149, v18, v19
    s_waitcnt vmcnt(6) lgkmcnt(15)
    v_mfma_f32_16x16x32_bf16 v[100:103], v[80:83], v[20:23], v[100:103]
    ds_read_b64_tr_b16 v[80:81], v144 offset:40960
    ds_read_b64_tr_b16 v[82:83], v144 offset:43520
    v_mfma_f32_16x16x32_bf16 v[104:107], v[84:87], v[20:23], v[104:107]
    ds_read_b64_tr_b16 v[84:85], v144 offset:40992
    ds_read_b64_tr_b16 v[86:87], v144 offset:43552
    v_mfma_f32_16x16x32_bf16 v[108:111], v[88:91], v[20:23], v[108:111]
    ds_read_b64_tr_b16 v[88:89], v145 offset:40960
    ds_read_b64_tr_b16 v[90:91], v145 offset:43520
    v_mfma_f32_16x16x32_bf16 v[112:115], v[92:95], v[20:23], v[112:115]
    ds_read_b64_tr_b16 v[92:93], v145 offset:40992
    ds_read_b64_tr_b16 v[94:95], v145 offset:43552
    v_max3_u32 v149, v149, v20, v21
    v_mfma_f32_16x16x32_bf16 v[116:119], v[96:99], v[20:23], v[116:119]
    ds_read_b64_tr_b16 v[96:97], v146 offset:41088
    ds_read_b64_tr_b16 v[98:99], v146 offset:43648
    v_max3_u32 v149, v149, v22, v23
    s_waitcnt vmcnt(5) lgkmcnt(15)
    v_mfma_f32_16x16x32_bf16 v[100:103], v[40:43], v[24:27], v[100:103]
    ds_read_b64_tr_b16 v[40:41], v144 offset:46080
    ds_read_b64_tr_b16 v[42:43], v144 offset:48640
    v_mfma_f32_16x16x32_bf16 v[104:107], v[44:47], v[24:27], v[104:107]
    ds_read_b64_tr_b16 v[44:45], v144 offset:46112
    ds_read_b64_tr_b16 v[46:47], v144 offset:48672
    v_mfma_f32_16x16x32_bf16 v[108:111], v[48:51], v[24:27], v[108:111]
    ds_read_b64_tr_b16 v[48:49], v145 offset:46080
    ds_read_b64_tr_b16 v[50:51], v145 offset:48640
    v_mfma_f32_16x16x32_bf16 v[112:115], v[52:55], v[24:27], v[112:115]
    ds_read_b64_tr_b16 v[52:53], v145 offset:46112
    ds_read_b64_tr_b16 v[54:55], v145 offset:48672
    v_max3_u32 v149, v149, v24, v25
    v_mfma_f32_16x16x32_bf16 v[116:119], v[56:59], v[24:27], v[116:119]
    ds_read_b64_tr_b16 v[56:57], v146 offset:46208
    ds_read_b64_tr_b16 v[58:59], v146 offset:48768
    v_max3_u32 v149, v149, v26, v27
    s_waitcnt vmcnt(4) lgkmcnt(15)
    v_mfma_f32_16x16x32_bf16 v[100:103], v[60:63], v[28:31], v[100:103]
    v_mfma_f32_16x16x32_bf16 v[104:107], v[64:67], v[28:31], v[104:107]
    v_mfma_f32_16x16x32_bf16 v[108:111], v[68:71], v[28:31], v[108:111]
    v_mfma_f32_16x16x32_bf16 v[112:115], v[72:75], v[28:31], v[112:115]
    v_max3_u32 v149, v149, v28, v29
    v_mfma_f32_16x16x32_bf16 v[116:119], v[76:79], v[28:31], v[116:119]
    v_max3_u32 v149, v149, v30, v31
    s_waitcnt vmcnt(2) lgkmcnt(10)
    v_mfma_f32_16x16x32_bf16 v[100:103], v[80:83], v[32:35], v[100:103]
    v_mfma_f32_16x16x32_bf16 v[104:107], v[84:87], v[32:35], v[104:107]
    v_mfma_f32_16x16x32_bf16 v[108:111], v[88:91], v[32:35], v[108:111]
    v_mfma_f32_16x16x32_bf16 v[112:115], v[92:95], v[32:35], v[112:115]
    v_max3_u32 v149, v149, v32, v33
    v_mfma_f32_16x16x32_bf16 v[116:119], v[96:99], v[32:35], v[116:119]
    v_max3_u32 v149, v149, v34, v35
    s_waitcnt vmcnt(0) lgkmcnt(0)
    v_mfma_f32_16x16x32_bf16 v[100:103], v[40:43], v[36:39], v[100:103]
    v_mfma_f32_16x16x32_bf16 v[104:107], v[44:47], v[36:39], v[104:107]
    v_mfma_f32_16x16x32_bf16 v[108:111], v[48:51], v[36:39], v[108:111]
    v_mfma_f32_16x16x32_bf16 v[112:115], v[52:55], v[36:39], v[112:115]
    v_max3_u32 v149, v149, v36, v37
    v_mfma_f32_16x16x32_bf16 v[116:119], v[56:59], v[36:39], v[116:119]
    v_max3_u32 v149, v149, v38, v39
    v_cmp_eq_u32 vcc, -1, v149
    s_nop 0
    s_cbranch_vccz L_WO_OK
    s_add_u32 s93, s93, 1
    s_cmp_gt_u32 s93, 16384
    s_cbranch_scc1 L_WO_OK
    ds_read_b64_tr_b16 v[40:41], v144 offset:0
    ds_read_b64_tr_b16 v[42:43], v144 offset:2560
    ds_read_b64_tr_b16 v[44:45], v144 offset:32
    ds_read_b64_tr_b16 v[46:47], v144 offset:2592
    ds_read_b64_tr_b16 v[48:49], v145 offset:0
    ds_read_b64_tr_b16 v[50:51], v145 offset:2560
    ds_read_b64_tr_b16 v[52:53], v145 offset:32
    ds_read_b64_tr_b16 v[54:55], v145 offset:2592
    ds_read_b64_tr_b16 v[56:57], v146 offset:128
    ds_read_b64_tr_b16 v[58:59], v146 offset:2688
    ds_read_b64_tr_b16 v[60:61], v144 offset:5120
    ds_read_b64_tr_b16 v[62:63], v144 offset:7680
    ds_read_b64_tr_b16 v[64:65], v144 offset:5152
    ds_read_b64_tr_b16 v[66:67], v144 offset:7712
    ds_read_b64_tr_b16 v[68:69], v145 offset:5120
    ds_read_b64_tr_b16 v[70:71], v145 offset:7680
    ds_read_b64_tr_b16 v[72:73], v145 offset:5152
    ds_read_b64_tr_b16 v[74:75], v145 offset:7712
    ds_read_b64_tr_b16 v[76:77], v146 offset:5248
    ds_read_b64_tr_b16 v[78:79], v146 offset:7808
    ds_read_b64_tr_b16 v[80:81], v144 offset:10240
    ds_read_b64_tr_b16 v[82:83], v144 offset:12800
    ds_read_b64_tr_b16 v[84:85], v144 offset:10272
    ds_read_b64_tr_b16 v[86:87], v144 offset:12832
    ds_read_b64_tr_b16 v[88:89], v145 offset:10240
    ds_read_b64_tr_b16 v[90:91], v145 offset:12800
    ds_read_b64_tr_b16 v[92:93], v145 offset:10272
    ds_read_b64_tr_b16 v[94:95], v145 offset:12832
    ds_read_b64_tr_b16 v[96:97], v146 offset:10368
    ds_read_b64_tr_b16 v[98:99], v146 offset:12928
    s_branch L_WO_LD
L_WO_OK:
    s_mul_i32 s84, s6, 3072
    v_add_u32 v150, s84, v153
    s_xor_b32 s84, s6, 4
    s_mul_i32 s84, s84, 3072
    v_add_u32 v151, s84, v153
    ds_write_b128 v150, v[108:111] offset:0
    ds_write_b128 v150, v[112:115] offset:1024
    ds_write_b128 v150, v[116:119] offset:2048
    v_add_f32 v120, v120, v100
    v_add_f32 v121, v121, v101
    v_add_f32 v122, v122, v102
    v_add_f32 v123, v123, v103
    v_add_f32 v124, v124, v104
    v_add_f32 v125, v125, v105
    v_add_f32 v126, v126, v106
    v_add_f32 v127, v127, v107
    v_add_f32 v128, v128, v116
    v_add_f32 v129, v129, v117
    v_add_f32 v130, v130, v118
    v_add_f32 v131, v131, v119
    s_waitcnt lgkmcnt(0)
    s_barrier
    ds_read_b128 v[0:3], v151 offset:0
    ds_read_b128 v[4:7], v151 offset:1024
    ds_read_b128 v[8:11], v151 offset:2048
    s_lshl_b32 s83, s38, 2
    s_add_u32 s83, s83, s88
    s_mul_i32 s83, s83, 20480
    s_mul_i32 s84, s39, 2560
    s_add_u32 s83, s83, s84
    s_add_u32 s83, s83, s7
    s_add_u32 s83, s83, 7929856
    s_lshl_b32 s84, s87, 10
    s_add_u32 s84, s84, s83
    v_lshrrev_b32 v154, 1, v147
    v_and_b32 v155, 1, v147
    v_lshlrev_b32 v156, 4, v148
    v_lshl_add_u32 v156, v154, 8, v156
    v_lshl_add_u32 v157, v155, 9, v156
    v_lshl_add_u32 v156, v155, 3, v156
    v_lshlrev_b32 v158, 4, v244
    v_lshl_add_u32 v158, v147, 2, v158
    s_lshl_b32 s85, s3, 15
    s_add_u32 s85, s85, 131072
    s_waitcnt lgkmcnt(1)
    v_add_f32 v120, v120, v0
    v_add_f32 v121, v121, v1
    v_add_f32 v122, v122, v2
    v_add_f32 v123, v123, v3
    v_add_f32 v124, v124, v4
    v_add_f32 v125, v125, v5
    v_add_f32 v126, v126, v6
    v_add_f32 v127, v127, v7
    v_cvt_pk_bf16_f32 v238, v120, v121
    v_cvt_pk_bf16_f32 v239, v122, v123
    v_cvt_pk_bf16_f32 v240, v124, v125
    v_cvt_pk_bf16_f32 v241, v126, v127
    v_add_f32 v20, v120, v121
    v_mul_f32 v21, v120, v120
    v_mul_f32 v22, v120, v132
    v_permlane16_swap_b32 v238, v240
    v_permlane16_swap_b32 v239, v241
    v_fmac_f32 v21, v121, v121
    v_fmac_f32 v22, v121, v133
    buffer_store_dwordx4 v[238:241], v157, s[20:23], s84 offen sc1
    v_add_f32 v20, v20, v122
    v_fmac_f32 v21, v122, v122
    v_fmac_f32 v22, v122, v134
    v_add_f32 v20, v20, v123
    v_fmac_f32 v21, v123, v123
    v_fmac_f32 v22, v123, v135
    v_add_f32 v20, v20, v124
    v_fmac_f32 v21, v124, v124
    v_fmac_f32 v22, v124, v136
    v_add_f32 v20, v20, v125
    v_fmac_f32 v21, v125, v125
    v_fmac_f32 v22, v125, v137
    v_add_f32 v20, v20, v126
    v_fmac_f32 v21, v126, v126
    v_fmac_f32 v22, v126, v138
    v_add_f32 v20, v20, v127
    v_fmac_f32 v21, v127, v127
    v_fmac_f32 v22, v127, v139
    s_cmp_lg_u32 s87, 0
    s_waitcnt lgkmcnt(0)
    s_cbranch_scc1 L_WO_T4
    v_add_f32 v128, v128, v8
    v_add_f32 v129, v129, v9
    v_add_f32 v130, v130, v10
    v_add_f32 v131, v131, v11
    v_cvt_pk_bf16_f32 v242, v128, v129
    v_cvt_pk_bf16_f32 v243, v130, v131
    buffer_store_dwordx2 v[242:243], v156, s[20:23], s83 offen offset:2048 sc1
    v_add_f32 v20, v20, v128
    v_fmac_f32 v21, v128, v128
    v_fmac_f32 v22, v128, v140
    v_add_f32 v20, v20, v129
    v_fmac_f32 v21, v129, v129
    v_fmac_f32 v22, v129, v141
    v_add_f32 v20, v20, v130
    v_fmac_f32 v21, v130, v130
    v_fmac_f32 v22, v130, v142
    v_add_f32 v20, v20, v131
    v_fmac_f32 v21, v131, v131
    v_fmac_f32 v22, v131, v143
L_WO_T4:
    v_mov_b32 v23, 0.5
    v_permlane16_swap_b32 v20, v21
    s_nop 0
    v_permlane16_swap_b32 v22, v23
    v_add_f32 v20, v20, v21
    v_add_f32 v22, v22, v23
    s_nop 1
    v_permlane32_swap_b32 v20, v22
    v_add_f32 v20, v20, v22
    buffer_atomic_add_f32 v20, v158, s[20:23], s85 offen
    s_add_u32 s83, s34, 0
    s_lshl_b32 s84, s38, 2
    s_add_u32 s84, s84, s88
    s_lshl_b32 s84, s84, 6
    s_add_u32 s84, s84, s34
    s_add_u32 s84, s84, 393216
    v_mov_b32 v150, 0
    s_mov_b64 exec, 1
    s_waitcnt vmcnt(1)
    buffer_atomic_add v249, v150, s[20:23], s84 offen
    s_mov_b64 exec, -1
    s_barrier
    s_cmp_lg_u32 s6, 4
    s_cbranch_scc1 L_WO_END
    s_mov_b32 exec_lo, s89
    s_mov_b32 exec_hi, 0
    s_cbranch_execz L_WO_E2
    buffer_atomic_add v249, v248, s[20:23], s83 offen
L_WO_E2:
    s_mov_b64 exec, -1
L_WO_END:
    s_lshl_b32 s82, s3, 8
    s_add_u32 s82, s82, s2
    s_cmp_ge_u32 s82, 192
    s_cbranch_scc1 L_NOT_G
    s_mov_b32 s3, 1
    s_mov_b32 s34, 32
    s_mov_b32 s7, 20971520
    s_branch L_LAYER
L_NOT_G:
    s_cmp_ge_u32 s41, 48
    s_cbranch_scc1 L_NO_FFN
    v_mov_b32 v140, 0
    s_cmp_lg_u32 s3, 0
    s_cbranch_scc1 L_GU_X0
    s_cmp_lt_u32 s6, 4
    s_cselect_b64 s[28:29], s[46:47], s[48:49]
    s_mov_b32 s30, 1966080
    v_lshrrev_b32 v140, 2, v253
    v_mul_u32_u24 v140, 3072, v140
    v_and_b32 v141, 3, v253
    v_lshl_add_u32 v140, v141, 4, v140
    s_and_b32 s90, s6, 3
    s_mul_i32 s90, s90, 491520
    s_lshl_b32 s91, s41, 6
    s_add_u32 s90, s90, s91
    s_mul_i32 s91, s6, 10240
    s_add_u32 m0, s91, 40960
    s_nop 0
    buffer_load_dwordx4 v140, s[28:31], s90 offen lds
    s_add_u32 s90, s90, 49152
    s_add_u32 m0, m0, 1024
    s_nop 0
    buffer_load_dwordx4 v140, s[28:31], s90 offen lds
    s_add_u32 s90, s90, 49152
    s_add_u32 m0, m0, 1024
    s_nop 0
    buffer_load_dwordx4 v140, s[28:31], s90 offen lds
    s_add_u32 s90, s90, 49152
    s_add_u32 m0, m0, 1024
L_GU_X0:
    v_mov_b32 v96, 0
    v_mov_b32 v97, 0
    v_mov_b32 v98, 0
    v_mov_b32 v99, 0
    v_lshlrev_b32 v120, 4, v254
    v_add_u32 v121, 139264, v120
    ds_write_b128 v121, v[96:99]
    ds_write_b128 v121, v[96:99] offset:8192
    v_mov_b32 v121, 155648
    ds_write_b32 v121, v96 offset:64
    v_lshrrev_b32 v118, 4, v253
    v_and_b32 v119, 7, v253
    v_mov_b32 v0, s35
    v_mov_b32 v1, s35
    v_mov_b32 v2, s35
    v_mov_b32 v3, s35
    v_mov_b32 v4, s35
    v_mov_b32 v5, s35
    v_mov_b32 v6, s35
    v_mov_b32 v7, s35
    v_mov_b32 v8, s35
    v_mov_b32 v9, s35
    v_mov_b32 v10, s35
    v_mov_b32 v11, s35
    v_sub_u32 v112, 2047, v254
    v_sub_u32 v113, 1535, v254
    v_sub_u32 v114, 1023, v254
    v_sub_u32 v115, 511, v254
    v_mov_b32 v121, 0xfffff800
    s_lshl_b32 s83, s3, 15
    s_add_u32 s83, s83, 131072
    s_add_u32 s84, s83, 8192
    s_add_u32 s85, s83, 16384
    s_add_u32 s86, s83, 24576
    s_mov_b32 s82, 0
L_T8_PL:
    s_sleep 8
    buffer_load_dwordx4 v[96:99], v120, s[20:23], s83 offen sc1
    buffer_load_dwordx4 v[100:103], v120, s[20:23], s84 offen sc1
    buffer_load_dwordx4 v[104:107], v120, s[20:23], s85 offen sc1
    buffer_load_dwordx4 v[108:111], v120, s[20:23], s86 offen sc1
    s_add_u32 s82, s82, 1
    s_waitcnt vmcnt(0)
    v_min3_f32 v122, v99, v103, v107
    v_min_f32 v122, v122, v111
    v_cmp_gt_f32 vcc, 0x42000000, v122
    s_nop 0
    s_cbranch_vccz L_T8_PX
    s_cmp_gt_u32 s82, 131072
    s_cbranch_scc0 L_T8_PL
L_T8_PX:
    s_add_u32 s86, s34, 393216
    v_lshlrev_b32 v134, 6, v254
    v_mov_b32 v135, 16
    s_cmp_ge_u32 s6, 2
    s_cbranch_scc1 L_T8_K
    buffer_load_dword v135, v134, s[20:23], s86 offen sc1
L_T8_K:
    s_cmp_lg_u32 s3, 0
    s_cbranch_scc1 L_GU_X1
    buffer_load_dwordx4 v140, s[28:31], s90 offen lds
    s_add_u32 s90, s90, 49152
    s_add_u32 m0, m0, 1024
    s_nop 0
    buffer_load_dwordx4 v140, s[28:31], s90 offen lds
    s_add_u32 s90, s90, 49152
    s_add_u32 m0, m0, 1024
    s_nop 0
    buffer_load_dwordx4 v140, s[28:31], s90 offen lds
    s_add_u32 s90, s90, 49152
    s_add_u32 m0, m0, 1024
    s_nop 0
    buffer_load_dwordx4 v140, s[28:31], s90 offen lds
    s_add_u32 s90, s90, 49152
    s_add_u32 m0, m0, 1024
    s_nop 0
    buffer_load_dwordx4 v140, s[28:31], s90 offen lds
    s_add_u32 s90, s90, 49152
    s_add_u32 m0, m0, 1024
    s_nop 0
    buffer_load_dwordx4 v140, s[28:31], s90 offen lds
    s_add_u32 s90, s90, 49152
    s_add_u32 m0, m0, 1024
    s_nop 0
    buffer_load_dwordx4 v140, s[28:31], s90 offen lds
    s_add_u32 s90, s90, 49152
    s_add_u32 m0, m0, 1024
L_GU_X1:
    v_mul_f32 v96, 0x3acccccd, v96
    v_mul_f32 v100, 0x3acccccd, v100
    v_mul_f32 v104, 0x3acccccd, v104
    v_mul_f32 v108, 0x3acccccd, v108
    v_mul_f32 v97, 0x3acccccd, v97
    v_mul_f32 v101, 0x3acccccd, v101
    v_mul_f32 v105, 0x3acccccd, v105
    v_mul_f32 v109, 0x3acccccd, v109
    v_fma_f32 v97, -v96, v96, v97
    v_fma_f32 v101, -v100, v100, v101
    v_fma_f32 v105, -v104, v104, v105
    v_fma_f32 v109, -v108, v108, v109
    v_max_f32 v97, 0, v97
    v_max_f32 v101, 0, v101
    v_max_f32 v105, 0, v105
    v_max_f32 v109, 0, v109
    v_cvt_pk_bf16_f32 v101, v97, v101
    v_cvt_pk_bf16_f32 v109, v105, v109
    v_lshlrev_b32 v97, 16, v101
    v_and_b32 v101, 0xffff0000, v101
    v_lshlrev_b32 v105, 16, v109
    v_and_b32 v109, 0xffff0000, v109
    v_add_f32 v97, 0x3727c5ac, v97
    v_add_f32 v101, 0x3727c5ac, v101
    v_add_f32 v105, 0x3727c5ac, v105
    v_add_f32 v109, 0x3727c5ac, v109
    v_cvt_pk_bf16_f32 v101, v97, v101
    v_cvt_pk_bf16_f32 v109, v105, v109
    v_lshlrev_b32 v97, 16, v101
    v_and_b32 v101, 0xffff0000, v101
    v_lshlrev_b32 v105, 16, v109
    v_and_b32 v109, 0xffff0000, v109
    v_sqrt_f32 v97, v97
    v_sqrt_f32 v101, v101
    v_sqrt_f32 v105, v105
    v_sqrt_f32 v109, v109
    v_cvt_pk_bf16_f32 v100, v96, v100
    v_cvt_pk_bf16_f32 v108, v104, v108
    v_lshlrev_b32 v96, 16, v100
    v_and_b32 v100, 0xffff0000, v100
    v_lshlrev_b32 v104, 16, v108
    v_and_b32 v108, 0xffff0000, v108
    v_fma_f32 v98, -v96, s40, v98
    v_fma_f32 v102, -v100, s40, v102
    v_fma_f32 v106, -v104, s40, v106
    v_fma_f32 v110, -v108, s40, v110
    v_cvt_pk_bf16_f32 v101, v97, v101
    v_cvt_pk_bf16_f32 v109, v105, v109
    v_lshlrev_b32 v97, 16, v101
    v_and_b32 v101, 0xffff0000, v101
    v_lshlrev_b32 v105, 16, v109
    v_and_b32 v109, 0xffff0000, v109
    v_rcp_f32 v97, v97
    v_rcp_f32 v101, v101
    v_rcp_f32 v105, v105
    v_rcp_f32 v109, v109
    v_mul_f32 v98, v98, v97
    v_mul_f32 v102, v102, v101
    v_mul_f32 v106, v106, v105
    v_mul_f32 v110, v110, v109
    v_ashrrev_i32 v96, 31, v98
    v_ashrrev_i32 v100, 31, v102
    v_ashrrev_i32 v104, 31, v106
    v_ashrrev_i32 v108, 31, v110
    v_or_b32 v96, 0x80000000, v96
    v_or_b32 v100, 0x80000000, v100
    v_or_b32 v104, 0x80000000, v104
    v_or_b32 v108, 0x80000000, v108
    v_xor_b32 v96, v96, v98
    v_xor_b32 v100, v100, v102
    v_xor_b32 v104, v104, v106
    v_xor_b32 v108, v108, v110
    v_and_or_b32 v112, v96, v121, v112
    v_and_or_b32 v113, v100, v121, v113
    v_and_or_b32 v114, v104, v121, v114
    v_and_or_b32 v115, v108, v121, v115
    v_max_u32 v120, v112, v113
    v_max3_u32 v120, v120, v114, v115
    s_nop 1
    v_max_u32_dpp v120, v120, v120 row_ror:8 row_mask:0xf bank_mask:0xf
    s_nop 1
    v_max_u32_dpp v120, v120, v120 row_ror:4 row_mask:0xf bank_mask:0xf
    s_nop 1
    v_max_u32_dpp v120, v120, v120 row_ror:2 row_mask:0xf bank_mask:0xf
    s_nop 1
    v_max_u32_dpp v120, v120, v120 row_ror:1 row_mask:0xf bank_mask:0xf
    v_mov_b32 v121, v120
    v_lshrrev_b32 v122, 5, v254
    s_nop 0
    v_permlane16_swap_b32 v120, v121
    v_lshlrev_b32 v122, 2, v122
    v_max_u32 v120, v120, v121
    v_add_u32 v122, 155648, v122
    v_and_b32 v136, 15, v253
    ds_write_b32 v122, v120
    v_lshlrev_b32 v136, 2, v136
    v_lshlrev_b32 v137, 4, v118
    v_add_u32 v122, 155648, v136
    v_add_u32 v123, 155648, v137
    v_mov_b32 v121, 155680
    s_waitcnt lgkmcnt(0)
    s_barrier
    ds_read_b32 v120, v122
    ds_read_b128 v[96:99], v123
    v_mov_b32 v100, 0
    v_mov_b32 v101, 0
    s_waitcnt lgkmcnt(0)
    v_cmp_gt_u32 s[50:51], v96, v120
    v_cmp_gt_u32 s[52:53], v97, v120
    v_cmp_gt_u32 s[54:55], v98, v120
    v_cmp_gt_u32 s[56:57], v99, v120
    v_addc_co_u32 v100, vcc, 0, v100, s[50:51]
    v_addc_co_u32 v101, vcc, 0, v101, s[52:53]
    v_addc_co_u32 v100, vcc, 0, v100, s[54:55]
    v_addc_co_u32 v101, vcc, 0, v101, s[56:57]
    v_add_u32 v100, v100, v101
    v_mov_b32 v101, v100
    s_nop 1
    v_permlane16_swap_b32 v100, v101
    v_add_u32 v100, v100, v101
    v_mov_b32 v101, v100
    s_nop 1
    v_permlane32_swap_b32 v100, v101
    v_add_u32 v100, v100, v101
    v_cmp_eq_u32 vcc, 7, v100
    s_nop 0
    s_ff1_i32_b64 s83, vcc
    v_readlane_b32 s83, v120, s83
    s_nop 1
    v_mov_b32 v120, s83
    v_cmp_ge_u32 s[50:51], v112, v120
    v_cmp_ge_u32 s[52:53], v113, v120
    v_cmp_ge_u32 s[54:55], v114, v120
    v_cmp_ge_u32 s[56:57], v115, v120
    s_bcnt1_i32_b64 s58, s[50:51]
    s_bcnt1_i32_b64 s59, s[52:53]
    s_bcnt1_i32_b64 s60, s[54:55]
    s_bcnt1_i32_b64 s61, s[56:57]
    s_add_u32 s59, s59, s58
    s_add_u32 s60, s60, s59
    s_add_u32 s61, s61, s60
    v_mov_b32 v122, s61
    s_mov_b64 exec, 1
    ds_add_rtn_u32 v123, v121, v122 offset:32
    s_mov_b64 exec, -1
    v_mbcnt_lo_u32_b32 v96, s50, 0
    v_mbcnt_hi_u32_b32 v96, s51, v96
    v_lshlrev_b32 v96, 2, v96
    v_mbcnt_lo_u32_b32 v97, s52, 0
    v_mbcnt_hi_u32_b32 v97, s53, v97
    v_add_u32 v97, s58, v97
    v_lshlrev_b32 v97, 2, v97
    v_mbcnt_lo_u32_b32 v98, s54, 0
    v_mbcnt_hi_u32_b32 v98, s55, v98
    v_add_u32 v98, s59, v98
    v_lshlrev_b32 v98, 2, v98
    v_mbcnt_lo_u32_b32 v99, s56, 0
    v_mbcnt_hi_u32_b32 v99, s57, v99
    v_add_u32 v99, s60, v99
    v_lshlrev_b32 v99, 2, v99
    s_waitcnt lgkmcnt(0)
    v_readfirstlane_b32 s83, v123
    s_nop 0
    s_lshl_b32 s83, s83, 2
    s_add_u32 s83, s83, 139264
    v_add_u32 v96, s83, v96
    v_add_u32 v97, s83, v97
    v_add_u32 v98, s83, v98
    v_add_u32 v99, s83, v99
    s_mov_b64 exec, s[50:51]
    ds_write_b32 v96, v112
    s_mov_b64 exec, s[52:53]
    ds_write_b32 v97, v113
    s_mov_b64 exec, s[54:55]
    ds_write_b32 v98, v114
    s_mov_b64 exec, s[56:57]
    ds_write_b32 v99, v115
    s_mov_b64 exec, -1
    v_add_u32 v123, 139264, v136
    v_add_u32 v124, 139264, v137
    s_lshl_b32 s62, s6, 5
    s_add_u32 s62, s62, 156288
    s_mov_b32 s84, 0
    s_waitcnt vmcnt(0)
    v_cmp_ne_u32 vcc, 16, v135
    s_nop 0
    s_cbranch_vccz L_T8_K2
    s_mov_b32 exec_lo, 4294967295
    s_mov_b32 exec_hi, 4294967295
    s_mov_b32 s82, 0
POLL_12:
    buffer_load_dword v135, v134, s[20:23], s86 offen sc1
    s_add_u32 s82, s82, 1
    s_cmp_gt_u32 s82, 131072
    s_cbranch_scc1 POLLX_13
    s_waitcnt vmcnt(0)
    v_cmp_ne_u32 vcc, 16, v135
    s_nop 0
    s_cbranch_vccnz POLL_12
POLLX_13:
    s_waitcnt vmcnt(0)
    s_mov_b64 exec, -1
L_T8_K2:
    s_waitcnt lgkmcnt(0)
    s_barrier
    ds_read_b32 v122, v121 offset:32
L_T8_OUT:
    ds_read_b32 v112, v123
    v_mov_b32 v113, 0
    v_mov_b32 v114, 0
    v_mov_b32 v125, v124
    s_mov_b32 s85, 0
L_T8_IN:
    ds_read_b128 v[96:99], v125
    v_add_u32 v125, 64, v125
    s_add_u32 s85, s85, 16
    s_waitcnt lgkmcnt(0)
    v_readfirstlane_b32 s83, v122
    v_cmp_gt_u32 s[50:51], v96, v112
    v_cmp_gt_u32 s[52:53], v97, v112
    v_cmp_gt_u32 s[54:55], v98, v112
    v_cmp_gt_u32 s[56:57], v99, v112
    v_addc_co_u32 v113, vcc, 0, v113, s[50:51]
    v_addc_co_u32 v114, vcc, 0, v114, s[52:53]
    v_addc_co_u32 v113, vcc, 0, v113, s[54:55]
    v_addc_co_u32 v114, vcc, 0, v114, s[56:57]
    s_cmp_lt_u32 s85, s83
    s_cbranch_scc1 L_T8_IN
    v_add_u32 v113, v113, v114
    v_mov_b32 v114, v113
    s_nop 1
    v_permlane16_swap_b32 v113, v114
    v_add_u32 v113, v113, v114
    v_mov_b32 v114, v113
    s_nop 1
    v_permlane32_swap_b32 v113, v114
    v_add_u32 v113, v113, v114
    v_cmp_gt_u32 vcc, 8, v113
    v_lshlrev_b32 v113, 2, v113
    v_add_u32 v113, s62, v113
    s_mov_b64 exec, vcc
    ds_write_b32 v113, v112
    s_mov_b64 exec, -1
    v_add_u32 v123, 64, v123
    s_add_u32 s84, s84, 16
    s_cmp_lt_u32 s84, s83
    s_cbranch_scc1 L_T8_OUT
    v_lshlrev_b32 v120, 2, v119
    v_add_u32 v122, s62, v120
    ds_read_b32 v112, v122
    s_lshl_b32 s83, s6, 10
    s_add_u32 s83, s83, s7
    s_add_u32 s83, s83, 7929856
    s_add_u32 s84, s83, 8192
    s_add_u32 s85, s83, 16384
    s_lshl_b32 s86, s3, 15
    s_add_u32 s86, s86, 131072
    s_waitcnt lgkmcnt(0)
    v_and_b32 v121, 0x7ff, v112
    v_sub_u32 v121, 2047, v121
    v_lshrrev_b32 v127, 4, v121
    v_mul_u32_u24 v127, 20480, v127
    v_and_b32 v128, 15, v121
    v_lshl_add_u32 v127, v128, 4, v127
    v_lshl_add_u32 v127, v118, 8, v127
    v_lshlrev_b32 v121, 4, v121
    s_mov_b64 exec, 0xff
    buffer_load_dwordx2 v[96:97], v121, s[20:23], s86 offen sc1
    s_mov_b32 exec_lo, 0x00ff00ff
    s_mov_b32 exec_hi, 0x00ff00ff
    s_cmp_ge_u32 s6, 4
    s_cbranch_scc1 L_FF_G2
    buffer_load_dwordx4 v[8:11], v127, s[20:23], s85 offen sc1
L_FF_G2:
    buffer_load_dwordx4 v[0:3], v127, s[20:23], s83 offen sc1
    buffer_load_dwordx4 v[4:7], v127, s[20:23], s84 offen sc1
    s_mov_b64 exec, -1
    s_cmp_lg_u32 s6, 4
    s_cbranch_scc1 L_FF_P
    s_mul_i32 s83, s41, 512
    s_add_u32 s83, s83, s34
    s_add_u32 s83, s83, 32960
    s_mov_b64 exec, 0xff
    buffer_store_dword v112, v120, s[20:23], s83 offen sc1
    s_mov_b64 exec, -1
L_FF_P:
    s_cmp_lg_u32 s3, 0
    s_cbranch_scc1 L_GR_X
    v_lshrrev_b32 v141, 4, v253
    v_bfe_u32 v140, v253, 2, 2
    v_lshl_add_u32 v140, v141, 3, v140
    v_and_b32 v141, 3, v253
    v_lshlrev_b32 v141, 3, v141
    v_lshl_add_u32 v140, v140, 6, v141
    s_lshl_b32 s87, s6, 11
    s_add_u32 s87, s87, 40960
    v_add_u32 v140, s87, v140
    v_add_u32 v141, 40960, v140
    ds_read_b64_tr_b16 v[160:161], v140 offset:0
    ds_read_b64_tr_b16 v[162:163], v140 offset:256
    ds_read_b64_tr_b16 v[164:165], v140 offset:32
    ds_read_b64_tr_b16 v[166:167], v140 offset:288
    ds_read_b64_tr_b16 v[168:169], v141 offset:0
    ds_read_b64_tr_b16 v[170:171], v141 offset:256
    ds_read_b64_tr_b16 v[172:173], v141 offset:32
    ds_read_b64_tr_b16 v[174:175], v141 offset:288
    ds_read_b64_tr_b16 v[176:177], v140 offset:16384
    ds_read_b64_tr_b16 v[178:179], v140 offset:16640
    ds_read_b64_tr_b16 v[180:181], v140 offset:16416
    ds_read_b64_tr_b16 v[182:183], v140 offset:16672
    ds_read_b64_tr_b16 v[184:185], v141 offset:16384
    ds_read_b64_tr_b16 v[186:187], v141 offset:16640
    ds_read_b64_tr_b16 v[188:189], v141 offset:16416
    ds_read_b64_tr_b16 v[190:191], v141 offset:16672
    ds_read_b64_tr_b16 v[192:193], v140 offset:32768
    ds_read_b64_tr_b16 v[194:195], v140 offset:33024
    ds_read_b64_tr_b16 v[196:197], v140 offset:32800
    ds_read_b64_tr_b16 v[198:199], v140 offset:33056
    ds_read_b64_tr_b16 v[200:201], v141 offset:32768
    ds_read_b64_tr_b16 v[202:203], v141 offset:33024
    ds_read_b64_tr_b16 v[204:205], v141 offset:32800
    ds_read_b64_tr_b16 v[206:207], v141 offset:33056
L_GR_X:
    s_lshl_b32 s83, s6, 12
    v_lshlrev_b32 v129, 4, v253
    v_add_u32 v129, s83, v129
    v_and_b32 v130, 15, v253
    v_lshlrev_b32 v130, 3, v130
    v_lshl_add_u32 v130, v118, 8, v130
    s_lshl_b32 s83, s6, 10
    v_add_u32 v130, s83, v130
    v_lshrrev_b32 v131, 1, v118
    v_lshlrev_b32 v131, 7, v131
    v_bfe_u32 v132, v253, 1, 3
    v_lshl_add_u32 v131, v132, 4, v131
    v_and_b32 v132, 1, v118
    v_lshl_add_u32 v131, v132, 3, v131
    v_and_b32 v132, 1, v253
    v_lshl_add_u32 v131, v132, 2, v131
    s_lshl_b32 s83, s41, 1
    s_add_u32 s83, s83, s6
    s_lshl_b32 s83, s83, 8
    s_mul_i32 s84, s3, 24576
    s_add_u32 s83, s83, s84
    s_add_u32 s83, s83, 196608
    s_waitcnt vmcnt(2)
    v_mul_f32 v120, 0x3acccccd, v96
    v_mul_f32 v121, 0x3acccccd, v97
    v_fma_f32 v121, -v120, v120, v121
    v_max_f32 v121, 0, v121
    v_cvt_pk_bf16_f32 v116, v120, v120
    v_and_b32 v116, 0xffff0000, v116
    v_cvt_pk_bf16_f32 v122, v121, v121
    v_and_b32 v122, 0xffff0000, v122
    v_add_f32 v122, 0x3727c5ac, v122
    v_cvt_pk_bf16_f32 v122, v122, v122
    v_and_b32 v122, 0xffff0000, v122
    v_sqrt_f32 v117, v122
    s_nop 0
    v_cvt_pk_bf16_f32 v117, v117, v117
    v_and_b32 v117, 0xffff0000, v117
    v_rcp_f32 v117, v117
    v_mov_b32 v120, v116
    v_mov_b32 v121, v117
    s_nop 0
    v_permlane16_swap_b32 v116, v120
    v_permlane16_swap_b32 v117, v121
    v_mov_b32 v120, v116
    v_mov_b32 v121, v117
    s_nop 0
    v_permlane32_swap_b32 v116, v120
    v_permlane32_swap_b32 v117, v121
    s_cmp_eq_u32 s6, 4
    s_cbranch_scc1 L_FF_W4
    s_waitcnt vmcnt(0)
L_FF_W4:
    s_waitcnt vmcnt(1) lgkmcnt(0)
    v_mfma_f32_16x16x32_bf16 v[80:83], v[160:163], v[0:3], 0
    v_mfma_f32_16x16x32_bf16 v[84:87], v[164:167], v[0:3], 0
    v_mfma_f32_16x16x32_bf16 v[88:91], v[168:171], v[0:3], 0
    v_mfma_f32_16x16x32_bf16 v[92:95], v[172:175], v[0:3], 0
    v_mfma_f32_16x16x32_bf16 v[80:83], v[176:179], v[4:7], v[80:83]
    v_mfma_f32_16x16x32_bf16 v[84:87], v[180:183], v[4:7], v[84:87]
    v_mfma_f32_16x16x32_bf16 v[88:91], v[184:187], v[4:7], v[88:91]
    v_mfma_f32_16x16x32_bf16 v[92:95], v[188:191], v[4:7], v[92:95]
    s_cmp_ge_u32 s6, 4
    s_cbranch_scc1 L_FF_M2
    v_mfma_f32_16x16x32_bf16 v[80:83], v[192:195], v[8:11], v[80:83]
    v_mfma_f32_16x16x32_bf16 v[84:87], v[196:199], v[8:11], v[84:87]
    v_mfma_f32_16x16x32_bf16 v[88:91], v[200:203], v[8:11], v[88:91]
    v_mfma_f32_16x16x32_bf16 v[92:95], v[204:207], v[8:11], v[92:95]
L_FF_M2:
    s_nop 4
    v_mov_b32_dpp v100, v80 row_newbcast:8 row_mask:0xf bank_mask:0xf
    v_mov_b32_dpp v101, v81 row_newbcast:8 row_mask:0xf bank_mask:0xf
    v_mov_b32_dpp v102, v82 row_newbcast:8 row_mask:0xf bank_mask:0xf
    v_mov_b32_dpp v103, v83 row_newbcast:8 row_mask:0xf bank_mask:0xf
    v_fma_f32 v80, -v116, v100, v80
    v_fma_f32 v81, -v116, v101, v81
    v_fma_f32 v82, -v116, v102, v82
    v_fma_f32 v83, -v116, v103, v83
    v_mul_f32 v80, v117, v80
    v_mul_f32 v81, v117, v81
    v_mul_f32 v82, v117, v82
    v_mul_f32 v83, v117, v83
    ds_write_b128 v129, v[80:83] offset:0
    v_mov_b32_dpp v100, v84 row_newbcast:8 row_mask:0xf bank_mask:0xf
    v_mov_b32_dpp v101, v85 row_newbcast:8 row_mask:0xf bank_mask:0xf
    v_mov_b32_dpp v102, v86 row_newbcast:8 row_mask:0xf bank_mask:0xf
    v_mov_b32_dpp v103, v87 row_newbcast:8 row_mask:0xf bank_mask:0xf
    v_fma_f32 v84, -v116, v100, v84
    v_fma_f32 v85, -v116, v101, v85
    v_fma_f32 v86, -v116, v102, v86
    v_fma_f32 v87, -v116, v103, v87
    v_mul_f32 v84, v117, v84
    v_mul_f32 v85, v117, v85
    v_mul_f32 v86, v117, v86
    v_mul_f32 v87, v117, v87
    ds_write_b128 v129, v[84:87] offset:1024
    v_mov_b32_dpp v100, v88 row_newbcast:8 row_mask:0xf bank_mask:0xf
    v_mov_b32_dpp v101, v89 row_newbcast:8 row_mask:0xf bank_mask:0xf
    v_mov_b32_dpp v102, v90 row_newbcast:8 row_mask:0xf bank_mask:0xf
    v_mov_b32_dpp v103, v91 row_newbcast:8 row_mask:0xf bank_mask:0xf
    v_fma_f32 v88, -v116, v100, v88
    v_fma_f32 v89, -v116, v101, v89
    v_fma_f32 v90, -v116, v102, v90
    v_fma_f32 v91, -v116, v103, v91
    v_mul_f32 v88, v117, v88
    v_mul_f32 v89, v117, v89
    v_mul_f32 v90, v117, v90
    v_mul_f32 v91, v117, v91
    ds_write_b128 v129, v[88:91] offset:2048
    v_mov_b32_dpp v100, v92 row_newbcast:8 row_mask:0xf bank_mask:0xf
    v_mov_b32_dpp v101, v93 row_newbcast:8 row_mask:0xf bank_mask:0xf
    v_mov_b32_dpp v102, v94 row_newbcast:8 row_mask:0xf bank_mask:0xf
    v_mov_b32_dpp v103, v95 row_newbcast:8 row_mask:0xf bank_mask:0xf
    v_fma_f32 v92, -v116, v100, v92
    v_fma_f32 v93, -v116, v101, v93
    v_fma_f32 v94, -v116, v102, v94
    v_fma_f32 v95, -v116, v103, v95
    v_mul_f32 v92, v117, v92
    v_mul_f32 v93, v117, v93
    v_mul_f32 v94, v117, v94
    v_mul_f32 v95, v117, v95
    ds_write_b128 v129, v[92:95] offset:3072
    s_waitcnt lgkmcnt(0)
    s_barrier
    s_cmp_ge_u32 s6, 2
    s_cbranch_scc1 L_FF_H
    ds_read_b64 v[12:13], v130 offset:0
    ds_read_b64 v[14:15], v130 offset:4096
    ds_read_b64 v[16:17], v130 offset:8192
    ds_read_b64 v[18:19], v130 offset:12288
    ds_read_b64 v[20:21], v130 offset:16384
    ds_read_b64 v[22:23], v130 offset:20480
    ds_read_b64 v[24:25], v130 offset:24576
    ds_read_b64 v[26:27], v130 offset:28672
    ds_read_b64 v[28:29], v130 offset:2048
    ds_read_b64 v[30:31], v130 offset:6144
    ds_read_b64 v[32:33], v130 offset:10240
    ds_read_b64 v[34:35], v130 offset:14336
    ds_read_b64 v[36:37], v130 offset:18432
    ds_read_b64 v[38:39], v130 offset:22528
    ds_read_b64 v[40:41], v130 offset:26624
    ds_read_b64 v[42:43], v130 offset:30720
    s_waitcnt lgkmcnt(8)
    v_add_f32 v12, v12, v14
    v_add_f32 v13, v13, v15
    v_add_f32 v16, v16, v18
    v_add_f32 v17, v17, v19
    v_add_f32 v20, v20, v22
    v_add_f32 v21, v21, v23
    v_add_f32 v24, v24, v26
    v_add_f32 v25, v25, v27
    v_add_f32 v12, v12, v16
    v_add_f32 v13, v13, v17
    v_add_f32 v20, v20, v24
    v_add_f32 v21, v21, v25
    v_add_f32 v12, v12, v20
    v_add_f32 v13, v13, v21
    v_cvt_pk_bf16_f32 v13, v12, v13
    v_lshlrev_b32 v12, 16, v13
    v_and_b32 v13, 0xffff0000, v13
    v_mul_f32 v14, 0xbfb8aa3b, v12
    v_mul_f32 v15, 0xbfb8aa3b, v13
    v_exp_f32 v14, v14
    v_exp_f32 v15, v15
    s_waitcnt lgkmcnt(0)
    v_add_f32 v28, v28, v30
    v_add_f32 v29, v29, v31
    v_add_f32 v14, 1.0, v14
    v_add_f32 v32, v32, v34
    v_add_f32 v33, v33, v35
    v_add_f32 v15, 1.0, v15
    v_add_f32 v36, v36, v38
    v_add_f32 v37, v37, v39
    v_rcp_f32 v14, v14
    v_add_f32 v40, v40, v42
    v_add_f32 v41, v41, v43
    v_rcp_f32 v15, v15
    v_add_f32 v28, v28, v32
    v_add_f32 v29, v29, v33
    v_mul_f32 v12, v12, v14
    v_add_f32 v36, v36, v40
    v_add_f32 v37, v37, v41
    v_mul_f32 v13, v13, v15
    v_add_f32 v28, v28, v36
    v_add_f32 v29, v29, v37
    v_cvt_pk_bf16_f32 v13, v12, v13
    v_cvt_pk_bf16_f32 v29, v28, v29
    v_lshlrev_b32 v12, 16, v13
    v_and_b32 v13, 0xffff0000, v13
    v_lshlrev_b32 v28, 16, v29
    v_and_b32 v29, 0xffff0000, v29
    v_mul_f32 v12, v12, v28
    v_mul_f32 v13, v13, v29
    v_cvt_pk_bf16_f32 v12, v12, v13
    v_max_u32 v12, 1, v12
    buffer_store_dword v12, v131, s[20:23], s83 offen sc1
L_FF_H:
    s_barrier
L_NO_FFN:
    s_cmp_eq_u32 s3, 0
    s_cbranch_scc1 L_NO_EW
    s_lshr_b32 s87, s6, 2
    s_mov_b64 s[50:51], -1
    s_cmp_lt_u32 s41, 48
    s_cbranch_scc1 L_EW_F
    s_branch L_EW_G
L_EW_F:
    s_lshl_b32 s83, s6, 5
    s_add_u32 s83, s83, 156288
    v_mov_b32 v16, s83
    ds_read_b128 v[32:35], v16
    ds_read_b128 v[36:39], v16 offset:16
    v_sub_u32 v16, 2047, v244
    s_waitcnt lgkmcnt(0)
    v_and_b32 v32, 0x7ff, v32
    v_cmp_ne_u32 vcc, v32, v16
    s_nop 0
    s_and_b64 s[50:51], s[50:51], vcc
    v_and_b32 v33, 0x7ff, v33
    v_cmp_ne_u32 vcc, v33, v16
    s_nop 0
    s_and_b64 s[50:51], s[50:51], vcc
    v_and_b32 v34, 0x7ff, v34
    v_cmp_ne_u32 vcc, v34, v16
    s_nop 0
    s_and_b64 s[50:51], s[50:51], vcc
    v_and_b32 v35, 0x7ff, v35
    v_cmp_ne_u32 vcc, v35, v16
    s_nop 0
    s_and_b64 s[50:51], s[50:51], vcc
    v_and_b32 v36, 0x7ff, v36
    v_cmp_ne_u32 vcc, v36, v16
    s_nop 0
    s_and_b64 s[50:51], s[50:51], vcc
    v_and_b32 v37, 0x7ff, v37
    v_cmp_ne_u32 vcc, v37, v16
    s_nop 0
    s_and_b64 s[50:51], s[50:51], vcc
    v_and_b32 v38, 0x7ff, v38
    v_cmp_ne_u32 vcc, v38, v16
    s_nop 0
    s_and_b64 s[50:51], s[50:51], vcc
    v_and_b32 v39, 0x7ff, v39
    v_cmp_ne_u32 vcc, v39, v16
    s_nop 0
    s_and_b64 s[50:51], s[50:51], vcc
L_EW_G:
    s_mov_b32 s83, 163840
    v_lshlrev_b32 v16, 4, v244
    s_mov_b32 s85, s83
    v_mov_b32 v24, v16
    v_lshrrev_b32 v30, 4, v253
    v_lshrrev_b32 v20, 1, v30
    v_and_b32 v21, 1, v30
    v_mul_u32_u24 v22, 1280, v244
    v_lshl_add_u32 v23, v20, 4, v22
    v_lshl_add_u32 v23, v21, 5, v23
    v_lshl_add_u32 v22, v30, 3, v22
    s_mul_i32 s83, s39, 160
    s_lshl_b32 s84, s87, 6
    s_add_u32 s84, s84, s83
    s_add_u32 s83, s83, 128
    s_mov_b32 s82, 0
    s_cmp_lt_u32 s41, 48
    s_cbranch_scc1 L_EW_P1
L_EW_PL:
    s_sleep 20
L_EW_P1:
    buffer_load_dwordx4 v[0:3], v24, s[20:23], s85 offen sc1
    s_add_u32 s82, s82, 1
    s_waitcnt vmcnt(0)
    v_cmp_gt_f32 vcc, 0x42000000, v3
    s_nop 0
    s_cbranch_vccz L_EW_PX
    s_cmp_gt_u32 s82, 131072
    s_cbranch_scc0 L_EW_PL
L_EW_PX:
    v_mul_f32 v16, 0x3acccccd, v0
    v_mul_f32 v17, 0x3acccccd, v1
    v_fma_f32 v17, -v16, v16, v17
    v_max_f32 v17, 0, v17
    v_cvt_pk_bf16_f32 v4, v16, v16
    v_and_b32 v4, 0xffff0000, v4
    v_cvt_pk_bf16_f32 v18, v17, v17
    v_and_b32 v18, 0xffff0000, v18
    v_add_f32 v18, 0x3727c5ac, v18
    v_cvt_pk_bf16_f32 v18, v18, v18
    v_and_b32 v18, 0xffff0000, v18
    v_sqrt_f32 v5, v18
    s_nop 0
    v_cvt_pk_bf16_f32 v5, v5, v5
    v_and_b32 v5, 0xffff0000, v5
    v_rcp_f32 v5, v5
    v_lshlrev_b32 v16, 16, v238
    v_and_b32 v17, 0xffff0000, v238
    v_sub_f32 v18, v16, v4
    v_sub_f32 v19, v17, v4
    v_cvt_pk_bf16_f32 v19, v18, v19
    v_lshlrev_b32 v18, 16, v19
    v_and_b32 v19, 0xffff0000, v19
    v_mul_f32 v18, v18, v5
    v_mul_f32 v19, v19, v5
    v_cvt_pk_bf16_f32 v19, v18, v19
    v_lshlrev_b32 v18, 16, v19
    v_and_b32 v19, 0xffff0000, v19
    v_add_f32 v16, v16, v18
    v_add_f32 v17, v17, v19
    v_cvt_pk_bf16_f32 v8, v16, v17
    v_lshlrev_b32 v16, 16, v239
    v_and_b32 v17, 0xffff0000, v239
    v_sub_f32 v18, v16, v4
    v_sub_f32 v19, v17, v4
    v_cvt_pk_bf16_f32 v19, v18, v19
    v_lshlrev_b32 v18, 16, v19
    v_and_b32 v19, 0xffff0000, v19
    v_mul_f32 v18, v18, v5
    v_mul_f32 v19, v19, v5
    v_cvt_pk_bf16_f32 v19, v18, v19
    v_lshlrev_b32 v18, 16, v19
    v_and_b32 v19, 0xffff0000, v19
    v_add_f32 v16, v16, v18
    v_add_f32 v17, v17, v19
    v_cvt_pk_bf16_f32 v9, v16, v17
    v_lshlrev_b32 v16, 16, v240
    v_and_b32 v17, 0xffff0000, v240
    v_sub_f32 v18, v16, v4
    v_sub_f32 v19, v17, v4
    v_cvt_pk_bf16_f32 v19, v18, v19
    v_lshlrev_b32 v18, 16, v19
    v_and_b32 v19, 0xffff0000, v19
    v_mul_f32 v18, v18, v5
    v_mul_f32 v19, v19, v5
    v_cvt_pk_bf16_f32 v19, v18, v19
    v_lshlrev_b32 v18, 16, v19
    v_and_b32 v19, 0xffff0000, v19
    v_add_f32 v16, v16, v18
    v_add_f32 v17, v17, v19
    v_cvt_pk_bf16_f32 v10, v16, v17
    v_lshlrev_b32 v16, 16, v241
    v_and_b32 v17, 0xffff0000, v241
    v_sub_f32 v18, v16, v4
    v_sub_f32 v19, v17, v4
    v_cvt_pk_bf16_f32 v19, v18, v19
    v_lshlrev_b32 v18, 16, v19
    v_and_b32 v19, 0xffff0000, v19
    v_mul_f32 v18, v18, v5
    v_mul_f32 v19, v19, v5
    v_cvt_pk_bf16_f32 v19, v18, v19
    v_lshlrev_b32 v18, 16, v19
    v_and_b32 v19, 0xffff0000, v19
    v_add_f32 v16, v16, v18
    v_add_f32 v17, v17, v19
    v_cvt_pk_bf16_f32 v11, v16, v17
    s_mov_b64 exec, s[50:51]
    buffer_store_dwordx4 v[8:11], v23, s[24:27], s84 offen sc1
    s_cmp_lg_u32 s87, 0
    s_cbranch_scc1 L_EW_T4
    v_lshlrev_b32 v16, 16, v242
    v_and_b32 v17, 0xffff0000, v242
    v_sub_f32 v18, v16, v4
    v_sub_f32 v19, v17, v4
    v_cvt_pk_bf16_f32 v19, v18, v19
    v_lshlrev_b32 v18, 16, v19
    v_and_b32 v19, 0xffff0000, v19
    v_mul_f32 v18, v18, v5
    v_mul_f32 v19, v19, v5
    v_cvt_pk_bf16_f32 v19, v18, v19
    v_lshlrev_b32 v18, 16, v19
    v_and_b32 v19, 0xffff0000, v19
    v_add_f32 v16, v16, v18
    v_add_f32 v17, v17, v19
    v_cvt_pk_bf16_f32 v12, v16, v17
    v_lshlrev_b32 v16, 16, v243
    v_and_b32 v17, 0xffff0000, v243
    v_sub_f32 v18, v16, v4
    v_sub_f32 v19, v17, v4
    v_cvt_pk_bf16_f32 v19, v18, v19
    v_lshlrev_b32 v18, 16, v19
    v_and_b32 v19, 0xffff0000, v19
    v_mul_f32 v18, v18, v5
    v_mul_f32 v19, v19, v5
    v_cvt_pk_bf16_f32 v19, v18, v19
    v_lshlrev_b32 v18, 16, v19
    v_and_b32 v19, 0xffff0000, v19
    v_add_f32 v16, v16, v18
    v_add_f32 v17, v17, v19
    v_cvt_pk_bf16_f32 v13, v16, v17
    buffer_store_dwordx2 v[12:13], v22, s[24:27], s83 offen sc1
L_EW_T4:
    s_mov_b64 exec, -1
    s_cmp_lt_u32 s41, 48
    s_cbranch_scc1 L_EW_END
    s_mul_i32 s83, s38, 512
    s_add_u32 s83, s83, 56
    v_mov_b32 v16, 0
    v_mov_b32 v17, 1
    s_waitcnt vmcnt(0)
    s_barrier
    s_cmp_lg_u32 s6, 4
    s_cbranch_scc1 L_EW_END
    s_mov_b64 exec, 1
    buffer_atomic_add v17, v16, s[20:23], s83 offen
    s_mov_b64 exec, -1
L_EW_END:
L_NO_EW:
    s_cmp_lt_u32 s33, 30
    s_cbranch_scc1 L_NEXT
    s_cmp_lg_u32 s3, 0
    s_cbranch_scc1 L_SD_I
    s_cmp_lg_u32 s6, 0
    s_cbranch_scc1 L_SD_J
    s_mov_b32 s83, 1115136
    v_min_u32 v84, 63, v253
    v_lshlrev_b32 v84, 2, v84
    s_mov_b32 s82, 0
WI_14:
    buffer_load_dword v85, v84, s[20:23], s83 offen sc1
    s_add_u32 s82, s82, 1
    s_cmp_gt_u32 s82, 131072
    s_cbranch_scc1 WIX_15
    s_waitcnt vmcnt(0)
    v_cmp_ne_u32 vcc, s45, v85
    s_nop 0
    s_cbranch_vccz WIX_15
    s_sleep 8
    s_branch WI_14
WIX_15:
    s_waitcnt vmcnt(0)
L_SD_J:
    s_barrier
    s_mul_i32 s84, s6, 15360
    s_mov_b32 m0, s84
    s_mul_i32 s83, s44, 122880
    s_add_u32 s83, s83, s84
    s_add_u32 s83, s83, 2097152
    v_lshlrev_b32 v87, 4, v253
    buffer_load_dwordx4 v87, s[20:23], s83 offen offset:0 sc1 lds
    buffer_load_dwordx4 v87, s[20:23], s83 offen offset:1024 sc1 lds
    buffer_load_dwordx4 v87, s[20:23], s83 offen offset:2048 sc1 lds
    buffer_load_dwordx4 v87, s[20:23], s83 offen offset:3072 sc1 lds
    s_add_u32 m0, m0, 4096
    s_add_u32 s83, s83, 4096
    buffer_load_dwordx4 v87, s[20:23], s83 offen offset:0 sc1 lds
    buffer_load_dwordx4 v87, s[20:23], s83 offen offset:1024 sc1 lds
    buffer_load_dwordx4 v87, s[20:23], s83 offen offset:2048 sc1 lds
    buffer_load_dwordx4 v87, s[20:23], s83 offen offset:3072 sc1 lds
    s_add_u32 m0, m0, 4096
    s_add_u32 s83, s83, 4096
    buffer_load_dwordx4 v87, s[20:23], s83 offen offset:0 sc1 lds
    buffer_load_dwordx4 v87, s[20:23], s83 offen offset:1024 sc1 lds
    buffer_load_dwordx4 v87, s[20:23], s83 offen offset:2048 sc1 lds
    buffer_load_dwordx4 v87, s[20:23], s83 offen offset:3072 sc1 lds
    s_add_u32 m0, m0, 4096
    s_add_u32 s83, s83, 4096
    buffer_load_dwordx4 v87, s[20:23], s83 offen offset:0 sc1 lds
    buffer_load_dwordx4 v87, s[20:23], s83 offen offset:1024 sc1 lds
    buffer_load_dwordx4 v87, s[20:23], s83 offen offset:2048 sc1 lds
    v_lshrrev_b32 v84, 4, v253
    v_bfe_u32 v86, v253, 2, 2
    v_lshl_add_u32 v86, v84, 3, v86
    v_mul_u32_u24 v86, 80, v86
    v_and_b32 v84, 3, v253
    v_lshl_add_u32 v86, v84, 3, v86
    v_add_u32 v86, s84, v86
    s_waitcnt vmcnt(0)
    ds_read_b64_tr_b16 v[160:161], v86 offset:0
    ds_read_b64_tr_b16 v[162:163], v86 offset:320
    ds_read_b64_tr_b16 v[164:165], v86 offset:32
    ds_read_b64_tr_b16 v[166:167], v86 offset:352
    ds_read_b64_tr_b16 v[168:169], v86 offset:64
    ds_read_b64_tr_b16 v[170:171], v86 offset:384
    ds_read_b64_tr_b16 v[172:173], v86 offset:2560
    ds_read_b64_tr_b16 v[174:175], v86 offset:2880
    ds_read_b64_tr_b16 v[176:177], v86 offset:2592
    ds_read_b64_tr_b16 v[178:179], v86 offset:2912
    ds_read_b64_tr_b16 v[180:181], v86 offset:2624
    ds_read_b64_tr_b16 v[182:183], v86 offset:2944
    ds_read_b64_tr_b16 v[184:185], v86 offset:5120
    ds_read_b64_tr_b16 v[186:187], v86 offset:5440
    ds_read_b64_tr_b16 v[188:189], v86 offset:5152
    ds_read_b64_tr_b16 v[190:191], v86 offset:5472
    ds_read_b64_tr_b16 v[192:193], v86 offset:5184
    ds_read_b64_tr_b16 v[194:195], v86 offset:5504
    ds_read_b64_tr_b16 v[196:197], v86 offset:7680
    ds_read_b64_tr_b16 v[198:199], v86 offset:8000
    ds_read_b64_tr_b16 v[200:201], v86 offset:7712
    ds_read_b64_tr_b16 v[202:203], v86 offset:8032
    ds_read_b64_tr_b16 v[204:205], v86 offset:7744
    ds_read_b64_tr_b16 v[206:207], v86 offset:8064
    ds_read_b64_tr_b16 v[208:209], v86 offset:10240
    ds_read_b64_tr_b16 v[210:211], v86 offset:10560
    ds_read_b64_tr_b16 v[212:213], v86 offset:10272
    ds_read_b64_tr_b16 v[214:215], v86 offset:10592
    ds_read_b64_tr_b16 v[216:217], v86 offset:10304
    ds_read_b64_tr_b16 v[218:219], v86 offset:10624
    ds_read_b64_tr_b16 v[220:221], v86 offset:12800
    ds_read_b64_tr_b16 v[222:223], v86 offset:13120
    ds_read_b64_tr_b16 v[224:225], v86 offset:12832
    ds_read_b64_tr_b16 v[226:227], v86 offset:13152
    ds_read_b64_tr_b16 v[228:229], v86 offset:12864
    ds_read_b64_tr_b16 v[230:231], v86 offset:13184
    s_waitcnt lgkmcnt(0)
    s_barrier
L_SD_I:
    v_lshrrev_b32 v78, 4, v253
    v_lshlrev_b32 v78, 7, v78
    v_and_b32 v85, 7, v253
    v_lshl_add_u32 v78, v85, 4, v78
    v_bfe_u32 v85, v253, 3, 1
    v_lshl_add_u32 v78, v85, 9, v78
    s_mul_i32 s86, s6, 3072
    v_lshlrev_b32 v79, 4, v253
    v_add_u32 v79, s86, v79
    s_mul_i32 s84, s3, 24576
    s_add_u32 s86, s86, s84
    s_add_u32 s86, s86, 196608
    v_min_u32 v84, 159, v254
    v_mul_u32_u24 v72, 205, v84
    v_lshrrev_b32 v72, 12, v72
    v_mul_u32_u24 v73, 20, v72
    v_sub_u32 v73, v84, v73
    v_lshlrev_b32 v73, 1, v73
    v_lshrrev_b32 v74, 2, v73
    v_lshlrev_b32 v74, 8, v74
    v_lshl_add_u32 v74, v72, 4, v74
    v_and_b32 v84, 2, v73
    v_lshl_add_u32 v74, v84, 2, v74
    s_mul_i32 s83, s44, 512
    s_add_u32 s83, s83, s34
    s_add_u32 s83, s83, 32960
    v_lshlrev_b32 v84, 2, v72
    s_mov_b32 s82, 0
L_PFSI:
    buffer_load_dword v75, v84, s[20:23], s83 offen sc1
L_PWSI:
    s_add_u32 s82, s82, 1
    s_waitcnt vmcnt(0)
    v_min_u32 v85, v75, v75
    v_cmp_eq_u32 vcc, 0, v85
    s_nop 0
    s_cbranch_vccz L_PXSI
    s_cmp_gt_u32 s82, 131072
    s_sleep 1
    s_cbranch_scc0 L_PFSI
L_PXSI:
    s_cmp_ge_u32 s6, 3
    s_cbranch_scc1 L_SD_H
    v_and_b32 v75, 0x7ff, v75
    v_sub_u32 v75, 2047, v75
    v_lshrrev_b32 v84, 4, v75
    v_mul_u32_u24 v84, 20480, v84
    v_and_b32 v85, 15, v75
    v_lshl_add_u32 v84, v85, 4, v84
    v_lshrrev_b32 v85, 3, v73
    v_lshl_add_u32 v84, v85, 8, v84
    v_and_b32 v85, 7, v73
    v_lshl_add_u32 v84, v85, 1, v84
    s_mul_i32 s83, s44, 1280
    s_add_u32 s83, s83, s7
    s_add_u32 s83, s83, 7929856
    buffer_load_dword v69, v84, s[20:23], s83 offen sc1
    s_lshl_b32 s84, s3, 15
    s_add_u32 s84, s84, 131072
    v_lshlrev_b32 v84, 4, v75
    buffer_load_dwordx4 v[60:63], v84, s[20:23], s84 offen sc1
    v_lshrrev_b32 v80, 6, v75
    v_mul_u32_u24 v80, 512, v80
    s_mov_b32 s83, 56
    buffer_load_dword v81, v80, s[20:23], s83 offen sc1
    s_waitcnt vmcnt(0)
    buffer_load_dwordx4 v[0:3], v78, s[20:23], s86 offen offset:0 sc1
    buffer_load_dwordx4 v[8:11], v78, s[20:23], s86 offen offset:1024 sc1
    buffer_load_dwordx4 v[16:19], v78, s[20:23], s86 offen offset:2048 sc1
    v_mul_f32 v84, 0x3acccccd, v60
    v_mul_f32 v85, 0x3acccccd, v61
    v_fma_f32 v85, -v84, v84, v85
    v_max_f32 v85, 0, v85
    v_cvt_pk_bf16_f32 v64, v84, v84
    v_and_b32 v64, 0xffff0000, v64
    v_cvt_pk_bf16_f32 v86, v85, v85
    v_and_b32 v86, 0xffff0000, v86
    v_add_f32 v86, 0x3727c5ac, v86
    v_cvt_pk_bf16_f32 v86, v86, v86
    v_and_b32 v86, 0xffff0000, v86
    v_sqrt_f32 v65, v86
    s_nop 0
    v_cvt_pk_bf16_f32 v65, v65, v65
    v_and_b32 v65, 0xffff0000, v65
    v_rcp_f32 v84, v65
    v_mul_f32 v85, s40, v64
    v_sub_f32 v85, v62, v85
    v_mul_f32 v66, v85, v84
    v_cvt_pk_bf16_f32 v66, v66, v66
    v_and_b32 v66, 0xffff0000, v66
    v_rcp_f32 v65, v65
    v_mul_f32 v66, 0xbfb8aa3b, v66
    v_exp_f32 v66, v66
    v_lshlrev_b32 v68, 16, v69
    v_and_b32 v69, 0xffff0000, v69
    v_add_f32 v66, 1.0, v66
    v_rcp_f32 v66, v66
    v_sub_f32 v70, v68, v64
    v_sub_f32 v71, v69, v64
    v_cvt_pk_bf16_f32 v71, v70, v71
    v_lshlrev_b32 v70, 16, v71
    v_and_b32 v71, 0xffff0000, v71
    v_mul_f32 v70, v70, v65
    v_mul_f32 v71, v71, v65
    v_cvt_pk_bf16_f32 v71, v70, v71
    v_lshlrev_b32 v70, 16, v71
    v_and_b32 v71, 0xffff0000, v71
    v_cvt_pk_bf16_f32 v66, v66, v66
    v_and_b32 v66, 0xffff0000, v66
    s_mov_b32 s82, 0
    s_cmp_eq_u32 s3, 0
    s_cbranch_scc1 L_PWSH
    v_cmp_ne_u32 vcc, 8, v81
    s_nop 0
    s_cbranch_vccz L_PWSH
    s_mov_b32 exec_lo, 4294967295
    s_mov_b32 exec_hi, 4294967295
    s_mov_b32 s82, 0
POLL_16:
    buffer_load_dword v81, v80, s[20:23], s83 offen sc1
    s_add_u32 s82, s82, 1
    s_cmp_gt_u32 s82, 131072
    s_cbranch_scc1 POLLX_17
    s_waitcnt vmcnt(0)
    v_cmp_ne_u32 vcc, 8, v81
    s_nop 0
    s_cbranch_vccnz POLL_16
POLLX_17:
    s_waitcnt vmcnt(0)
    s_mov_b64 exec, -1
L_SD_H:
    s_mov_b32 s82, 0
L_PFSH:
    buffer_load_dwordx4 v[0:3], v78, s[20:23], s86 offen offset:0 sc1
    buffer_load_dwordx4 v[8:11], v78, s[20:23], s86 offen offset:1024 sc1
    buffer_load_dwordx4 v[16:19], v78, s[20:23], s86 offen offset:2048 sc1
L_PWSH:
    s_add_u32 s82, s82, 1
    s_waitcnt vmcnt(0)
    v_min3_u32 v85, v0, v1, v2
    v_min3_u32 v85, v85, v3, v8
    v_min3_u32 v85, v85, v9, v10
    v_min3_u32 v85, v85, v11, v16
    v_min3_u32 v85, v85, v17, v18
    v_min_u32 v85, v85, v19
    v_cmp_eq_u32 vcc, 0, v85
    s_nop 0
    s_cbranch_vccz L_PXSH
    s_cmp_gt_u32 s82, 131072
    s_cbranch_scc0 L_PFSH
L_PXSH:
    v_mfma_f32_16x16x32_bf16 v[24:27], v[160:163], v[0:3], 0
    v_mfma_f32_16x16x32_bf16 v[28:31], v[164:167], v[0:3], 0
    v_mfma_f32_16x16x32_bf16 v[32:35], v[168:171], v[0:3], 0
    v_mov_b32_dpp v4, v0 row_ror:8 row_mask:0xf bank_mask:0xf
    v_mov_b32_dpp v5, v1 row_ror:8 row_mask:0xf bank_mask:0xf
    v_mov_b32_dpp v6, v2 row_ror:8 row_mask:0xf bank_mask:0xf
    v_mov_b32_dpp v7, v3 row_ror:8 row_mask:0xf bank_mask:0xf
    v_mfma_f32_16x16x32_bf16 v[24:27], v[184:187], v[8:11], v[24:27]
    v_mfma_f32_16x16x32_bf16 v[28:31], v[188:191], v[8:11], v[28:31]
    v_mfma_f32_16x16x32_bf16 v[32:35], v[192:195], v[8:11], v[32:35]
    v_mov_b32_dpp v12, v8 row_ror:8 row_mask:0xf bank_mask:0xf
    v_mov_b32_dpp v13, v9 row_ror:8 row_mask:0xf bank_mask:0xf
    v_mov_b32_dpp v14, v10 row_ror:8 row_mask:0xf bank_mask:0xf
    v_mov_b32_dpp v15, v11 row_ror:8 row_mask:0xf bank_mask:0xf
    v_mfma_f32_16x16x32_bf16 v[24:27], v[208:211], v[16:19], v[24:27]
    v_mfma_f32_16x16x32_bf16 v[28:31], v[212:215], v[16:19], v[28:31]
    v_mfma_f32_16x16x32_bf16 v[32:35], v[216:219], v[16:19], v[32:35]
    v_mov_b32_dpp v20, v16 row_ror:8 row_mask:0xf bank_mask:0xf
    v_mov_b32_dpp v21, v17 row_ror:8 row_mask:0xf bank_mask:0xf
    v_mov_b32_dpp v22, v18 row_ror:8 row_mask:0xf bank_mask:0xf
    v_mov_b32_dpp v23, v19 row_ror:8 row_mask:0xf bank_mask:0xf
    v_mfma_f32_16x16x32_bf16 v[24:27], v[172:175], v[4:7], v[24:27]
    v_mfma_f32_16x16x32_bf16 v[28:31], v[176:179], v[4:7], v[28:31]
    v_mfma_f32_16x16x32_bf16 v[32:35], v[180:183], v[4:7], v[32:35]
    v_mfma_f32_16x16x32_bf16 v[24:27], v[196:199], v[12:15], v[24:27]
    v_mfma_f32_16x16x32_bf16 v[28:31], v[200:203], v[12:15], v[28:31]
    v_mfma_f32_16x16x32_bf16 v[32:35], v[204:207], v[12:15], v[32:35]
    v_mfma_f32_16x16x32_bf16 v[24:27], v[220:223], v[20:23], v[24:27]
    v_mfma_f32_16x16x32_bf16 v[28:31], v[224:227], v[20:23], v[28:31]
    v_mfma_f32_16x16x32_bf16 v[32:35], v[228:231], v[20:23], v[32:35]
    s_nop 5
    ds_write_b128 v79, v[24:27] offset:0
    ds_write_b128 v79, v[28:31] offset:1024
    ds_write_b128 v79, v[32:35] offset:2048
    s_waitcnt lgkmcnt(0)
    s_barrier
    s_cmp_ge_u32 s6, 3
    s_cbranch_scc1 L_SD_END
    ds_read_b64 v[40:41], v74 offset:0
    ds_read_b64 v[42:43], v74 offset:3072
    ds_read_b64 v[44:45], v74 offset:6144
    ds_read_b64 v[46:47], v74 offset:9216
    ds_read_b64 v[48:49], v74 offset:12288
    ds_read_b64 v[50:51], v74 offset:15360
    ds_read_b64 v[52:53], v74 offset:18432
    ds_read_b64 v[54:55], v74 offset:21504
    s_mul_i32 s83, s44, 80
    v_mul_u32_u24 v84, 1280, v75
    v_min_u32 v85, 159, v254
    v_lshl_add_u32 v84, v73, 1, v84
    v_lshlrev_b32 v85, 2, v85
    s_waitcnt lgkmcnt(0)
    v_add_f32 v40, v40, v42
    v_add_f32 v41, v41, v43
    v_add_f32 v44, v44, v46
    v_add_f32 v45, v45, v47
    v_add_f32 v48, v48, v50
    v_add_f32 v49, v49, v51
    v_add_f32 v52, v52, v54
    v_add_f32 v53, v53, v55
    v_add_f32 v40, v40, v44
    v_add_f32 v41, v41, v45
    v_add_f32 v48, v48, v52
    v_add_f32 v49, v49, v53
    v_add_f32 v40, v40, v48
    v_add_f32 v41, v41, v49
    v_cvt_pk_bf16_f32 v41, v40, v41
    v_lshlrev_b32 v40, 16, v41
    v_and_b32 v41, 0xffff0000, v41
    v_mul_f32 v40, v40, v66
    v_mul_f32 v41, v41, v66
    v_cvt_pk_bf16_f32 v41, v40, v41
    v_lshlrev_b32 v40, 16, v41
    v_and_b32 v41, 0xffff0000, v41
    v_add_f32 v40, v40, v70
    v_add_f32 v41, v41, v71
    v_cvt_pk_bf16_f32 v41, v40, v41
    v_lshlrev_b32 v40, 16, v41
    v_and_b32 v41, 0xffff0000, v41
    v_add_f32 v40, v40, v68
    v_add_f32 v41, v41, v69
    v_cvt_pk_bf16_f32 v40, v40, v41
    s_cmp_eq_u32 s3, 0
    s_cbranch_scc1 L_SD_Q
    buffer_store_dword v40, v84, s[24:27], s83 offen sc1
    s_branch L_SD_END
L_SD_Q:
    v_max_u32 v40, 1, v40
    s_lshl_b32 s83, s83, 3
    s_add_u32 s83, s83, 294912
    buffer_store_dword v40, v85, s[20:23], s83 offen sc1
    s_add_u32 s83, s83, 10240
    buffer_store_dword v40, v85, s[20:23], s83 offen sc1
    s_add_u32 s83, s83, 10240
    buffer_store_dword v40, v85, s[20:23], s83 offen sc1
    s_add_u32 s83, s83, 10240
    buffer_store_dword v40, v85, s[20:23], s83 offen sc1
    s_add_u32 s83, s83, 10240
    buffer_store_dword v40, v85, s[20:23], s83 offen sc1
    s_add_u32 s83, s83, 10240
    buffer_store_dword v40, v85, s[20:23], s83 offen sc1
    s_add_u32 s83, s83, 10240
    buffer_store_dword v40, v85, s[20:23], s83 offen sc1
    s_add_u32 s83, s83, 10240
    buffer_store_dword v40, v85, s[20:23], s83 offen sc1
    s_add_u32 s83, s83, 10240
L_SD_END:
    s_barrier
L_NEXT:
    s_cmp_lg_u32 s3, 0
    s_cbranch_scc1 L_FINISH
    s_mov_b32 s3, 1
    s_mov_b32 s34, 32
    s_mov_b32 s7, 20971520
    s_branch L_LAYER
L_FINISH:
    s_cmp_lg_u32 s2, 0
    s_cbranch_scc1 L_FINISH2
    s_cmp_lg_u32 s6, 4
    s_cbranch_scc1 L_FINISH2
    v_mov_b32 v0, s45
    v_mov_b32 v1, 1114048
    s_mov_b64 exec, 1
    buffer_store_dword v0, v1, s[20:23], 0 offen sc1
    s_mov_b64 exec, -1
L_FINISH2:
L_END:
    s_endpgm
.section .rodata,"a"
.p2align 6
.amdhsa_kernel interleave_layers__sliding_block__moe_arch_mod__prompt_kernel
  .amdhsa_next_free_vgpr 256
  .amdhsa_next_free_sgpr 102
  .amdhsa_accum_offset 256
  .amdhsa_group_segment_fixed_size 0
  .amdhsa_kernarg_size 88
  .amdhsa_user_sgpr_count 2
  .amdhsa_user_sgpr_kernarg_segment_ptr 1
  .amdhsa_system_sgpr_workgroup_id_x 1
  .amdhsa_float_denorm_mode_32 3
  .amdhsa_float_denorm_mode_16_64 3
.end_amdhsa_kernel
```
